```python
import torch

def _softmax(x, axis=-1):
    return torch.softmax(x, dim=axis)
def _gelu(x):
    return torch.nn.functional.gelu(x, approximate="tanh")
def _silu(x):
    return torch.nn.functional.silu(x)
def _sigmoid(x):
    return torch.sigmoid(x)
def _layernorm(x, axis=-1, eps=1e-5):
    m = x.mean(dim=axis, keepdim=True)
    v = x.var(dim=axis, keepdim=True, unbiased=False)
    return (x - m) / torch.sqrt(v + eps)
def _scatter_add(tgt, idx, src, axis=0):
    return tgt.clone().index_add_(axis, idx, src)
def _segment_sum(src, seg, n):
    out = torch.zeros((n,) + src.shape[1:], dtype=src.dtype)
    return out.index_add_(0, seg, src)
def _pad(x, pw):
    flat = tuple(v for pair in reversed(pw) for v in pair)
    return torch.nn.functional.pad(x, flat)

kernel_name = 'standalone__gqa_softmax__near_ridge'

def setup_inputs():

    _w = (lambda a: (lambda t: t.to(torch.bfloat16) if t.is_floating_point() else t)(torch.as_tensor(a)))
    B, Hq, Hkv, Sq, Sk, D = 64, 32, 32, 256, 256, 128
    return {
        "q": _w((lambda *s: torch.randn(*s, dtype=torch.bfloat16) * 0.8)(B, Hq, Sq, D)),
        "k": _w((lambda *s: torch.randn(*s, dtype=torch.bfloat16) * 0.8)(B, Hkv, Sk, D)),
        "v": _w((lambda *s: torch.randn(*s, dtype=torch.bfloat16) * 0.05)(B, Hkv, Sk, D)),
    }

def reference(q, k, v):
    B, Hq, Sq, D = q.shape
    Hkv = k.shape[1]
    rep = Hq // Hkv
    k = (lambda x, n, axis: torch.repeat_interleave(x, n, dim=axis))(k, rep, axis=1)
    v = (lambda x, n, axis: torch.repeat_interleave(x, n, dim=axis))(v, rep, axis=1)
    scale = D ** -0.5
    scores = torch.einsum("bhqd,bhkd->bhqk", q, k) * scale
    p = _softmax(scores, axis=-1)
    return torch.einsum("bhqk,bhkd->bhqd", p, v)
```

```asm
; @launch grid=(256,1,1) block=(512,1,1) lds=163840
.amdgcn_target "amdgcn-amd-amdhsa--gfx950"
.text
.globl standalone__gqa_softmax__near_ridge_kernel
.p2align 8
.type standalone__gqa_softmax__near_ridge_kernel,@function
standalone__gqa_softmax__near_ridge_kernel:
    s_cmp_ge_u32 s2, 256
    s_cbranch_scc1 L_end
    s_load_dwordx8 s[36:43], s[0:1], 0
    v_lshrrev_b32 v1, 6, v0
    v_and_b32 v2, 63, v0
    v_readfirstlane_b32 s30, v1
    v_and_b32 v3, 15, v2
    v_lshrrev_b32 v6, 4, v2
    v_lshrrev_b32 v4, 5, v2
    s_and_b32 s45, s2, 7
    s_lshl_b32 s45, s45, 5
    s_lshr_b32 s20, s2, 3
    s_add_u32 s20, s20, s45
    s_lshl_b32 s20, s20, 16
    s_add_u32 s21, s20, 16777216
    s_mov_b32 s29, 134217728
    s_lshl_b32 s23, s30, 11
    s_add_u32 s22, s23, 0x10000
    s_and_b32 s45, s30, 1
    s_lshl_b32 s45, s45, 3
    v_or_b32 v8, s45, v6
    v_xor_b32 v8, v8, v3
    v_lshlrev_b32 v8, 4, v8
    v_lshl_or_b32 v8, v6, 8, v8
    s_mul_i32 s46, s30, 2048
    v_add_u32 v236, s46, v8
    v_xor_b32 v237, 64, v236
    s_waitcnt lgkmcnt(0)
    s_mov_b32 s4, s36
    s_and_b32 s5, s37, 0xffff
    s_mov_b32 s6, s29
    s_mov_b32 s7, 0x00020000
    s_mov_b32 s8, s38
    s_and_b32 s9, s39, 0xffff
    s_mov_b32 s10, s29
    s_mov_b32 s11, 0x00020000
    s_mov_b32 m0, s23
    s_nop 0
    buffer_load_dwordx4 v236, s[8:11], s20 offen nt lds
    buffer_load_dwordx4 v237, s[8:11], s20 offen offset:1024 nt lds
    s_mov_b32 m0, s22
    s_nop 0
    buffer_load_dwordx4 v236, s[4:7], s20 offen nt lds
    buffer_load_dwordx4 v237, s[4:7], s20 offen offset:1024 nt lds
    s_add_u32 m0, s22, 16384
    s_add_u32 s27, s20, 16384
    buffer_load_dwordx4 v236, s[4:7], s27 offen nt lds
    buffer_load_dwordx4 v237, s[4:7], s27 offen offset:1024 nt lds
    s_add_u32 m0, s22, 32768
    s_add_u32 s27, s20, 32768
    buffer_load_dwordx4 v236, s[4:7], s27 offen nt lds
    buffer_load_dwordx4 v237, s[4:7], s27 offen offset:1024 nt lds
    s_add_u32 m0, s22, 49152
    s_add_u32 s27, s20, 49152
    buffer_load_dwordx4 v236, s[4:7], s27 offen nt lds
    buffer_load_dwordx4 v237, s[4:7], s27 offen offset:1024 nt lds
    s_add_u32 m0, s23, 32768
    s_add_u32 s27, s20, 16384
    buffer_load_dwordx4 v236, s[8:11], s27 offen nt lds
    buffer_load_dwordx4 v237, s[8:11], s27 offen offset:1024 nt lds
    s_xor_b32 s22, s22, 0x10000
    s_xor_b32 s23, s23, 0x10000
    s_mov_b32 s12, s40
    s_and_b32 s13, s41, 0xffff
    s_mov_b32 s14, s29
    s_mov_b32 s15, 0x00020000
    s_mov_b32 s16, s42
    s_and_b32 s17, s43, 0xffff
    s_mov_b32 s18, 0
    s_mov_b32 s19, 0x00020000
    v_xor_b32 v7, v6, v3
    v_lshlrev_b32 v7, 4, v7
    v_lshl_or_b32 v224, v3, 8, v7
    v_xor_b32 v225, 64, v224
    v_xor_b32 v226, 128, v224
    v_xor_b32 v227, 192, v224
    v_bfe_u32 v8, v2, 2, 2
    v_lshl_add_u32 v9, v6, 2, v8
    v_and_b32 v10, 7, v9
    v_lshlrev_b32 v10, 1, v10
    v_bfe_u32 v11, v2, 1, 1
    v_xor_b32 v10, v10, v11
    v_lshlrev_b32 v10, 4, v10
    v_lshl_or_b32 v10, v9, 8, v10
    v_and_b32 v11, 1, v2
    v_lshl_or_b32 v228, v11, 3, v10
    v_xor_b32 v229, 32, v228
    v_xor_b32 v230, 64, v228
    v_xor_b32 v231, 96, v228
    v_xor_b32 v232, 128, v228
    v_xor_b32 v233, 160, v228
    v_xor_b32 v234, 192, v228
    v_xor_b32 v235, 224, v228
    s_lshl_b32 s32, s30, 14
    s_lshl_b32 s44, s30, 13
    s_sub_u32 s24, s44, 0x10000
    s_lshl_b32 s47, s30, 12
    s_add_u32 s47, s47, 0x20000
    v_lshlrev_b32 v8, 1, v6
    v_xor_b32 v8, v8, v3
    v_lshlrev_b32 v8, 4, v8
    v_lshl_or_b32 v8, v6, 8, v8
    s_mul_i32 s46, s30, 2048
    v_add_u32 v238, s46, v8
    v_xor_b32 v239, 128, v238
    v_and_b32 v9, 7, v2
    v_xor_b32 v11, v4, v9
    v_lshlrev_b32 v11, 4, v11
    v_lshl_or_b32 v11, v3, 8, v11
    v_bfe_u32 v12, v2, 4, 1
    v_lshl_or_b32 v11, v12, 3, v11
    v_add_u32 v252, s47, v11
    v_xor_b32 v10, v3, v6
    v_lshlrev_b32 v10, 4, v10
    v_lshl_or_b32 v10, v6, 8, v10
    v_add_u32 v253, s44, v10
    v_xor_b32 v253, 64, v253
    v_add_u32 v241, s44, v10
    v_lshlrev_b32 v10, 4, v2
    v_add_u32 v240, s47, v10
    s_add_u32 m0, s22, 49152
    s_nop 0
    buffer_load_dwordx4 v238, s[12:15], s20 offen nt lds
    buffer_load_dwordx4 v239, s[12:15], s20 offen offset:1024 nt lds
    s_add_u32 s45, s44, 0x10000
    v_add_u32 v192, s45, v224
    v_add_u32 v193, s45, v225
    v_add_u32 v194, s45, v226
    v_add_u32 v195, s45, v227
    s_mov_b32 s26, 0x3e0293ee
    s_mov_b32 s31, 0xbe0293ee
    s_mov_b32 s62, 0x3e0293ee
    s_mov_b32 s63, 0x3e0293ee
    s_mov_b32 s35, 0x41800000
    s_mov_b32 s33, 0
    s_mov_b32 s34, 0
    s_mov_b32 s25, 0
    s_waitcnt vmcnt(4)
    s_barrier
    ds_read_b128 v[128:131], v192 offset:0
    ds_read_b128 v[132:135], v193 offset:0
    ds_read_b128 v[136:139], v194 offset:0
    ds_read_b128 v[140:143], v195 offset:0
    ds_read_b128 v[144:147], v192 offset:4096
    ds_read_b128 v[148:151], v193 offset:4096
    ds_read_b128 v[152:155], v194 offset:4096
    ds_read_b128 v[156:159], v195 offset:4096
    s_waitcnt lgkmcnt(0)
    s_barrier
L_entry:
    ds_read_b128 v[160:163], v224 offset:0
    ds_read_b128 v[164:167], v225 offset:0
    ds_read_b128 v[168:171], v226 offset:0
    ds_read_b128 v[172:175], v227 offset:0
    s_waitcnt lgkmcnt(3)
    v_mfma_f32_16x16x32_bf16 v[0:3], v[160:163], v[128:131], 0
    v_mfma_f32_16x16x32_bf16 v[8:11], v[160:163], v[144:147], 0
    ds_read_b128 v[176:179], v224 offset:4096
    s_waitcnt lgkmcnt(3)
    v_mfma_f32_16x16x32_bf16 v[0:3], v[164:167], v[132:135], v[0:3]
    v_mfma_f32_16x16x32_bf16 v[8:11], v[164:167], v[148:151], v[8:11]
    ds_read_b128 v[180:183], v225 offset:4096
    s_mov_b32 m0, s23
    s_add_u32 s27, s20, 32768
    buffer_load_dwordx4 v236, s[8:11], s27 offen nt lds
    s_waitcnt lgkmcnt(3)
    v_mfma_f32_16x16x32_bf16 v[0:3], v[168:171], v[136:139], v[0:3]
    v_mfma_f32_16x16x32_bf16 v[8:11], v[168:171], v[152:155], v[8:11]
    ds_read_b128 v[184:187], v226 offset:4096
    s_waitcnt lgkmcnt(3)
    v_mfma_f32_16x16x32_bf16 v[0:3], v[172:175], v[140:143], v[0:3]
    v_mfma_f32_16x16x32_bf16 v[8:11], v[172:175], v[156:159], v[8:11]
    ds_read_b128 v[188:191], v227 offset:4096
    s_waitcnt lgkmcnt(3)
    v_mfma_f32_16x16x32_bf16 v[4:7], v[176:179], v[128:131], 0
    v_mfma_f32_16x16x32_bf16 v[12:15], v[176:179], v[144:147], 0
    ds_read_b128 v[160:163], v224 offset:8192
    s_waitcnt lgkmcnt(3)
    v_mfma_f32_16x16x32_bf16 v[4:7], v[180:183], v[132:135], v[4:7]
    v_mfma_f32_16x16x32_bf16 v[12:15], v[180:183], v[148:151], v[12:15]
    ds_read_b128 v[164:167], v225 offset:8192
    buffer_load_dwordx4 v237, s[8:11], s27 offen offset:1024 nt lds
    s_waitcnt lgkmcnt(3)
    v_mfma_f32_16x16x32_bf16 v[4:7], v[184:187], v[136:139], v[4:7]
    v_mfma_f32_16x16x32_bf16 v[12:15], v[184:187], v[152:155], v[12:15]
    ds_read_b128 v[168:171], v226 offset:8192
    s_waitcnt lgkmcnt(3)
    v_mfma_f32_16x16x32_bf16 v[4:7], v[188:191], v[140:143], v[4:7]
    v_mfma_f32_16x16x32_bf16 v[12:15], v[188:191], v[156:159], v[12:15]
    ds_read_b128 v[172:175], v227 offset:8192
    s_waitcnt lgkmcnt(3)
    v_mfma_f32_16x16x32_bf16 v[16:19], v[160:163], v[128:131], 0
    v_mfma_f32_16x16x32_bf16 v[24:27], v[160:163], v[144:147], 0
    ds_read_b128 v[176:179], v224 offset:12288
    s_waitcnt lgkmcnt(3)
    v_mfma_f32_16x16x32_bf16 v[16:19], v[164:167], v[132:135], v[16:19]
    v_mfma_f32_16x16x32_bf16 v[24:27], v[164:167], v[148:151], v[24:27]
    ds_read_b128 v[180:183], v225 offset:12288
    s_waitcnt lgkmcnt(3)
    v_mfma_f32_16x16x32_bf16 v[16:19], v[168:171], v[136:139], v[16:19]
    v_mfma_f32_16x16x32_bf16 v[24:27], v[168:171], v[152:155], v[24:27]
    ds_read_b128 v[184:187], v226 offset:12288
    v_max_f32 v242, v0, v1
    v_max_f32 v243, v8, v9
    v_max3_f32 v242, v242, v2, v3
    v_max3_f32 v243, v243, v10, v11
    v_max3_f32 v242, v242, v4, v5
    v_max3_f32 v243, v243, v12, v13
    v_max3_f32 v242, v242, v6, v7
    v_max3_f32 v243, v243, v14, v15
    s_waitcnt lgkmcnt(3)
    v_mfma_f32_16x16x32_bf16 v[16:19], v[172:175], v[140:143], v[16:19]
    v_mfma_f32_16x16x32_bf16 v[24:27], v[172:175], v[156:159], v[24:27]
    ds_read_b128 v[188:191], v227 offset:12288
    s_waitcnt lgkmcnt(3)
    v_mfma_f32_16x16x32_bf16 v[20:23], v[176:179], v[128:131], 0
    v_mfma_f32_16x16x32_bf16 v[28:31], v[176:179], v[144:147], 0
    s_waitcnt vmcnt(4) lgkmcnt(0)
    s_barrier
    ds_read_b128 v[160:163], v224 offset:32768
    v_mfma_f32_16x16x32_bf16 v[20:23], v[180:183], v[132:135], v[20:23]
    v_mfma_f32_16x16x32_bf16 v[28:31], v[180:183], v[148:151], v[28:31]
    ds_read_b128 v[164:167], v225 offset:32768
    v_mfma_f32_16x16x32_bf16 v[20:23], v[184:187], v[136:139], v[20:23]
    v_mfma_f32_16x16x32_bf16 v[28:31], v[184:187], v[152:155], v[28:31]
    ds_read_b128 v[168:171], v226 offset:32768
    v_mfma_f32_16x16x32_bf16 v[20:23], v[188:191], v[140:143], v[20:23]
    v_mfma_f32_16x16x32_bf16 v[28:31], v[188:191], v[156:159], v[28:31]
    ds_read_b128 v[172:175], v227 offset:32768
    s_add_u32 m0, s23, 16384
    s_add_u32 s27, s20, 16384
    buffer_load_dwordx4 v238, s[12:15], s27 offen nt lds
    buffer_load_dwordx4 v239, s[12:15], s27 offen offset:1024 nt lds
    s_mov_b32 m0, s22
    s_nop 0
    buffer_load_dwordx4 v236, s[4:7], s21 offen nt lds
    buffer_load_dwordx4 v237, s[4:7], s21 offen offset:1024 nt lds
    s_waitcnt lgkmcnt(3)
    v_mfma_f32_16x16x32_bf16 v[32:35], v[160:163], v[128:131], 0
    v_mfma_f32_16x16x32_bf16 v[40:43], v[160:163], v[144:147], 0
    ds_read_b128 v[176:179], v224 offset:36864
    s_waitcnt lgkmcnt(3)
    v_mfma_f32_16x16x32_bf16 v[32:35], v[164:167], v[132:135], v[32:35]
    v_mfma_f32_16x16x32_bf16 v[40:43], v[164:167], v[148:151], v[40:43]
    ds_read_b128 v[180:183], v225 offset:36864
    s_add_u32 m0, s23, 32768
    s_add_u32 s27, s20, 49152
    buffer_load_dwordx4 v236, s[8:11], s27 offen nt lds
    v_max3_f32 v242, v242, v16, v17
    v_max3_f32 v243, v243, v24, v25
    v_max3_f32 v242, v242, v18, v19
    v_max3_f32 v243, v243, v26, v27
    v_max3_f32 v242, v242, v20, v21
    v_max3_f32 v243, v243, v28, v29
    s_waitcnt lgkmcnt(3)
    v_mfma_f32_16x16x32_bf16 v[32:35], v[168:171], v[136:139], v[32:35]
    v_mfma_f32_16x16x32_bf16 v[40:43], v[168:171], v[152:155], v[40:43]
    ds_read_b128 v[184:187], v226 offset:36864
    v_max3_f32 v242, v242, v22, v23
    v_max3_f32 v243, v243, v30, v31
    v_mov_b32 v250, v242
    v_mov_b32 v251, v243
    v_mov_b32 v246, 0
    v_permlane16_swap_b32 v250, v242
    v_permlane16_swap_b32 v251, v243
    s_waitcnt lgkmcnt(3)
    v_mfma_f32_16x16x32_bf16 v[32:35], v[172:175], v[140:143], v[32:35]
    v_mfma_f32_16x16x32_bf16 v[40:43], v[172:175], v[156:159], v[40:43]
    ds_read_b128 v[188:191], v227 offset:36864
    v_max_f32 v242, v242, v250
    v_max_f32 v243, v243, v251
    v_mov_b32 v250, v242
    v_mov_b32 v251, v243
    v_mov_b32 v247, 0
    v_permlane32_swap_b32 v250, v242
    s_waitcnt lgkmcnt(3)
    v_mfma_f32_16x16x32_bf16 v[36:39], v[176:179], v[128:131], 0
    v_mfma_f32_16x16x32_bf16 v[44:47], v[176:179], v[144:147], 0
    ds_read_b128 v[160:163], v224 offset:40960
    v_permlane32_swap_b32 v251, v243
    v_max_f32 v242, v242, v250
    v_max_f32 v243, v243, v251
    v_mul_f32 v244, s31, v242
    v_mul_f32 v245, s31, v243
    v_fma_f32 v0, v0, s26, v244
    s_waitcnt lgkmcnt(3)
    v_mfma_f32_16x16x32_bf16 v[36:39], v[180:183], v[132:135], v[36:39]
    v_mfma_f32_16x16x32_bf16 v[44:47], v[180:183], v[148:151], v[44:47]
    ds_read_b128 v[164:167], v225 offset:40960
    buffer_load_dwordx4 v237, s[8:11], s27 offen offset:1024 nt lds
    v_fma_f32 v1, v1, s26, v244
    v_exp_f32 v0, v0
    v_fma_f32 v2, v2, s26, v244
    v_exp_f32 v1, v1
    v_fma_f32 v3, v3, s26, v244
    v_exp_f32 v2, v2
    s_waitcnt lgkmcnt(3)
    v_mfma_f32_16x16x32_bf16 v[36:39], v[184:187], v[136:139], v[36:39]
    v_mfma_f32_16x16x32_bf16 v[44:47], v[184:187], v[152:155], v[44:47]
    ds_read_b128 v[168:171], v226 offset:40960
    v_add_f32 v246, v246, v0
    v_fma_f32 v4, v4, s26, v244
    v_exp_f32 v3, v3
    v_add_f32 v246, v246, v1
    v_fma_f32 v5, v5, s26, v244
    v_exp_f32 v4, v4
    s_waitcnt lgkmcnt(3)
    v_mfma_f32_16x16x32_bf16 v[36:39], v[188:191], v[140:143], v[36:39]
    v_mfma_f32_16x16x32_bf16 v[44:47], v[188:191], v[156:159], v[44:47]
    ds_read_b128 v[172:175], v227 offset:40960
    v_add_f32 v246, v246, v2
    v_cvt_pk_bf16_f32 v0, v0, v1
    v_fma_f32 v6, v6, s26, v244
    v_exp_f32 v5, v5
    v_add_f32 v246, v246, v3
    v_fma_f32 v7, v7, s26, v244
    v_exp_f32 v6, v6
    s_waitcnt lgkmcnt(3)
    v_mfma_f32_16x16x32_bf16 v[48:51], v[160:163], v[128:131], 0
    v_mfma_f32_16x16x32_bf16 v[56:59], v[160:163], v[144:147], 0
    ds_read_b128 v[176:179], v224 offset:45056
    v_add_f32 v246, v246, v4
    v_cvt_pk_bf16_f32 v1, v2, v3
    v_exp_f32 v7, v7
    v_add_f32 v246, v246, v5
    v_add_f32 v246, v246, v6
    v_cvt_pk_bf16_f32 v2, v4, v5
    s_waitcnt lgkmcnt(3)
    v_mfma_f32_16x16x32_bf16 v[48:51], v[164:167], v[132:135], v[48:51]
    v_mfma_f32_16x16x32_bf16 v[56:59], v[164:167], v[148:151], v[56:59]
    ds_read_b128 v[180:183], v225 offset:45056
    s_add_u32 m0, s22, 16384
    s_add_u32 s27, s21, 16384
    buffer_load_dwordx4 v236, s[4:7], s27 offen nt lds
    v_add_f32 v246, v246, v7
    v_cvt_pk_bf16_f32 v3, v6, v7
    v_fma_f32 v8, v8, s26, v245
    v_fma_f32 v9, v9, s26, v245
    v_exp_f32 v8, v8
    v_fma_f32 v10, v10, s26, v245
    s_waitcnt lgkmcnt(3)
    v_mfma_f32_16x16x32_bf16 v[48:51], v[168:171], v[136:139], v[48:51]
    v_mfma_f32_16x16x32_bf16 v[56:59], v[168:171], v[152:155], v[56:59]
    ds_read_b128 v[184:187], v226 offset:45056
    v_exp_f32 v9, v9
    v_fma_f32 v11, v11, s26, v245
    v_exp_f32 v10, v10
    v_add_f32 v247, v247, v8
    v_fma_f32 v12, v12, s26, v245
    v_exp_f32 v11, v11
    s_waitcnt lgkmcnt(3)
    v_mfma_f32_16x16x32_bf16 v[48:51], v[172:175], v[140:143], v[48:51]
    v_mfma_f32_16x16x32_bf16 v[56:59], v[172:175], v[156:159], v[56:59]
    ds_read_b128 v[188:191], v227 offset:45056
    v_add_f32 v247, v247, v9
    v_fma_f32 v13, v13, s26, v245
    v_exp_f32 v12, v12
    v_add_f32 v247, v247, v10
    v_cvt_pk_bf16_f32 v8, v8, v9
    v_fma_f32 v14, v14, s26, v245
    s_waitcnt lgkmcnt(3)
    v_mfma_f32_16x16x32_bf16 v[52:55], v[176:179], v[128:131], 0
    v_mfma_f32_16x16x32_bf16 v[60:63], v[176:179], v[144:147], 0
    s_waitcnt vmcnt(9) lgkmcnt(0)
    s_barrier
    ds_read_b64_tr_b16 v[160:161], v228 offset:49152
    ds_read_b64_tr_b16 v[162:163], v228 offset:53248
    v_exp_f32 v13, v13
    v_add_f32 v247, v247, v11
    v_fma_f32 v15, v15, s26, v245
    v_exp_f32 v14, v14
    v_add_f32 v247, v247, v12
    v_cvt_pk_bf16_f32 v9, v10, v11
    v_exp_f32 v15, v15
    v_mfma_f32_16x16x32_bf16 v[52:55], v[180:183], v[132:135], v[52:55]
    v_mfma_f32_16x16x32_bf16 v[60:63], v[180:183], v[148:151], v[60:63]
    ds_read_b64_tr_b16 v[164:165], v229 offset:49152
    ds_read_b64_tr_b16 v[166:167], v229 offset:53248
    buffer_load_dwordx4 v237, s[4:7], s27 offen offset:1024 nt lds
    v_add_f32 v247, v247, v13
    v_add_f32 v247, v247, v14
    v_cvt_pk_bf16_f32 v10, v12, v13
    v_add_f32 v247, v247, v15
    v_cvt_pk_bf16_f32 v11, v14, v15
    v_fma_f32 v16, v16, s26, v244
    v_mfma_f32_16x16x32_bf16 v[52:55], v[184:187], v[136:139], v[52:55]
    v_mfma_f32_16x16x32_bf16 v[60:63], v[184:187], v[152:155], v[60:63]
    ds_read_b64_tr_b16 v[168:169], v230 offset:49152
    ds_read_b64_tr_b16 v[170:171], v230 offset:53248
    v_fma_f32 v17, v17, s26, v244
    v_exp_f32 v16, v16
    v_fma_f32 v18, v18, s26, v244
    v_exp_f32 v17, v17
    v_fma_f32 v19, v19, s26, v244
    v_exp_f32 v18, v18
    v_mfma_f32_16x16x32_bf16 v[52:55], v[188:191], v[140:143], v[52:55]
    v_mfma_f32_16x16x32_bf16 v[60:63], v[188:191], v[156:159], v[60:63]
    ds_read_b64_tr_b16 v[172:173], v231 offset:49152
    ds_read_b64_tr_b16 v[174:175], v231 offset:53248
    v_add_f32 v246, v246, v16
    v_fma_f32 v20, v20, s26, v244
    v_exp_f32 v19, v19
    v_add_f32 v246, v246, v17
    v_fma_f32 v21, v21, s26, v244
    v_exp_f32 v20, v20
    s_waitcnt lgkmcnt(6)
    v_mfma_f32_16x16x32_bf16 v[64:67], v[160:163], v[0:3], 0
    v_mfma_f32_16x16x32_bf16 v[68:71], v[160:163], v[8:11], 0
    ds_read_b64_tr_b16 v[176:177], v232 offset:49152
    ds_read_b64_tr_b16 v[178:179], v232 offset:53248
    v_add_f32 v246, v246, v18
    v_cvt_pk_bf16_f32 v16, v16, v17
    v_fma_f32 v22, v22, s26, v244
    v_exp_f32 v21, v21
    v_add_f32 v246, v246, v19
    v_fma_f32 v23, v23, s26, v244
    s_waitcnt lgkmcnt(6)
    v_mfma_f32_16x16x32_bf16 v[72:75], v[164:167], v[0:3], 0
    v_mfma_f32_16x16x32_bf16 v[76:79], v[164:167], v[8:11], 0
    ds_read_b64_tr_b16 v[180:181], v233 offset:49152
    ds_read_b64_tr_b16 v[182:183], v233 offset:53248
    s_add_u32 m0, s23, 49152
    s_add_u32 s27, s20, 32768
    buffer_load_dwordx4 v238, s[12:15], s27 offen nt lds
    v_exp_f32 v22, v22
    v_add_f32 v246, v246, v20
    v_cvt_pk_bf16_f32 v17, v18, v19
    v_exp_f32 v23, v23
    v_add_f32 v246, v246, v21
    v_add_f32 v246, v246, v22
    v_cvt_pk_bf16_f32 v18, v20, v21
    s_waitcnt lgkmcnt(6)
    v_mfma_f32_16x16x32_bf16 v[80:83], v[168:171], v[0:3], 0
    v_mfma_f32_16x16x32_bf16 v[84:87], v[168:171], v[8:11], 0
    ds_read_b64_tr_b16 v[184:185], v234 offset:49152
    ds_read_b64_tr_b16 v[186:187], v234 offset:53248
    v_add_f32 v246, v246, v23
    v_cvt_pk_bf16_f32 v19, v22, v23
    v_fma_f32 v24, v24, s26, v245
    v_fma_f32 v25, v25, s26, v245
    v_exp_f32 v24, v24
    v_fma_f32 v26, v26, s26, v245
    s_waitcnt lgkmcnt(6)
    v_mfma_f32_16x16x32_bf16 v[88:91], v[172:175], v[0:3], 0
    v_mfma_f32_16x16x32_bf16 v[92:95], v[172:175], v[8:11], 0
    ds_read_b64_tr_b16 v[188:189], v235 offset:49152
    ds_read_b64_tr_b16 v[190:191], v235 offset:53248
    v_exp_f32 v25, v25
    v_fma_f32 v27, v27, s26, v245
    v_exp_f32 v26, v26
    v_add_f32 v247, v247, v24
    v_fma_f32 v28, v28, s26, v245
    v_exp_f32 v27, v27
    s_waitcnt lgkmcnt(6)
    v_mfma_f32_16x16x32_bf16 v[96:99], v[176:179], v[0:3], 0
    v_mfma_f32_16x16x32_bf16 v[100:103], v[176:179], v[8:11], 0
    ds_read_b64_tr_b16 v[160:161], v228 offset:57344
    ds_read_b64_tr_b16 v[162:163], v228 offset:61440
    v_add_f32 v247, v247, v25
    v_fma_f32 v29, v29, s26, v245
    v_exp_f32 v28, v28
    v_add_f32 v247, v247, v26
    v_cvt_pk_bf16_f32 v24, v24, v25
    v_fma_f32 v30, v30, s26, v245
    v_xor_b32 v224, 0x10000, v224
    s_waitcnt lgkmcnt(6)
    v_mfma_f32_16x16x32_bf16 v[104:107], v[180:183], v[0:3], 0
    v_mfma_f32_16x16x32_bf16 v[108:111], v[180:183], v[8:11], 0
    ds_read_b64_tr_b16 v[164:165], v229 offset:57344
    ds_read_b64_tr_b16 v[166:167], v229 offset:61440
    buffer_load_dwordx4 v239, s[12:15], s27 offen offset:1024 nt lds
    v_exp_f32 v29, v29
    v_add_f32 v247, v247, v27
    v_fma_f32 v31, v31, s26, v245
    v_exp_f32 v30, v30
    v_add_f32 v247, v247, v28
    v_cvt_pk_bf16_f32 v25, v26, v27
    v_xor_b32 v225, 0x10000, v225
    s_waitcnt lgkmcnt(6)
    v_mfma_f32_16x16x32_bf16 v[112:115], v[184:187], v[0:3], 0
    v_mfma_f32_16x16x32_bf16 v[116:119], v[184:187], v[8:11], 0
    ds_read_b64_tr_b16 v[168:169], v230 offset:57344
    ds_read_b64_tr_b16 v[170:171], v230 offset:61440
    v_exp_f32 v31, v31
    v_add_f32 v247, v247, v29
    v_add_f32 v247, v247, v30
    v_cvt_pk_bf16_f32 v26, v28, v29
    v_add_f32 v247, v247, v31
    v_cvt_pk_bf16_f32 v27, v30, v31
    v_max_f32 v242, v32, v33
    v_xor_b32 v226, 0x10000, v226
    s_waitcnt lgkmcnt(6)
    v_mfma_f32_16x16x32_bf16 v[120:123], v[188:191], v[0:3], 0
    v_mfma_f32_16x16x32_bf16 v[124:127], v[188:191], v[8:11], 0
    ds_read_b64_tr_b16 v[172:173], v231 offset:57344
    ds_read_b64_tr_b16 v[174:175], v231 offset:61440
    v_max_f32 v243, v40, v41
    v_max3_f32 v242, v242, v34, v35
    v_max3_f32 v243, v243, v42, v43
    v_max3_f32 v242, v242, v36, v37
    v_max3_f32 v243, v243, v44, v45
    v_max3_f32 v242, v242, v38, v39
    v_xor_b32 v227, 0x10000, v227
    s_waitcnt lgkmcnt(6)
    v_mfma_f32_16x16x32_bf16 v[64:67], v[160:163], v[16:19], v[64:67]
    v_mfma_f32_16x16x32_bf16 v[68:71], v[160:163], v[24:27], v[68:71]
    ds_read_b64_tr_b16 v[176:177], v232 offset:57344
    ds_read_b64_tr_b16 v[178:179], v232 offset:61440
    v_max3_f32 v243, v243, v46, v47
    v_max3_f32 v242, v242, v48, v49
    v_max3_f32 v243, v243, v56, v57
    v_max3_f32 v242, v242, v50, v51
    v_max3_f32 v243, v243, v58, v59
    v_max3_f32 v242, v242, v52, v53
    s_waitcnt lgkmcnt(6)
    v_mfma_f32_16x16x32_bf16 v[72:75], v[164:167], v[16:19], v[72:75]
    v_mfma_f32_16x16x32_bf16 v[76:79], v[164:167], v[24:27], v[76:79]
    ds_read_b64_tr_b16 v[180:181], v233 offset:57344
    ds_read_b64_tr_b16 v[182:183], v233 offset:61440
    s_add_u32 m0, s22, 32768
    s_add_u32 s27, s21, 32768
    buffer_load_dwordx4 v236, s[4:7], s27 offen nt lds
    v_max3_f32 v243, v243, v60, v61
    v_max3_f32 v242, v242, v54, v55
    v_max3_f32 v243, v243, v62, v63
    v_fma_f32 v250, v242, s26, v244
    v_fma_f32 v251, v243, s26, v245
    s_waitcnt lgkmcnt(6)
    v_mfma_f32_16x16x32_bf16 v[80:83], v[168:171], v[16:19], v[80:83]
    v_mfma_f32_16x16x32_bf16 v[84:87], v[168:171], v[24:27], v[84:87]
    ds_read_b64_tr_b16 v[184:185], v234 offset:57344
    ds_read_b64_tr_b16 v[186:187], v234 offset:61440
    v_max_f32 v250, v250, v251
    v_cmp_lt_f32 vcc, s35, v250
    s_cbranch_vccnz L_rareF1
L_backF1:
    v_fma_f32 v32, v32, s26, v244
    v_fma_f32 v33, v33, s26, v244
    s_waitcnt lgkmcnt(6)
    v_mfma_f32_16x16x32_bf16 v[88:91], v[172:175], v[16:19], v[88:91]
    v_mfma_f32_16x16x32_bf16 v[92:95], v[172:175], v[24:27], v[92:95]
    ds_read_b64_tr_b16 v[188:189], v235 offset:57344
    ds_read_b64_tr_b16 v[190:191], v235 offset:61440
    v_exp_f32 v32, v32
    v_fma_f32 v34, v34, s26, v244
    v_exp_f32 v33, v33
    v_fma_f32 v35, v35, s26, v244
    v_exp_f32 v34, v34
    s_waitcnt lgkmcnt(6)
    v_mfma_f32_16x16x32_bf16 v[96:99], v[176:179], v[16:19], v[96:99]
    v_mfma_f32_16x16x32_bf16 v[100:103], v[176:179], v[24:27], v[100:103]
    s_waitcnt vmcnt(11) lgkmcnt(0)
    s_barrier
    ds_read_b128 v[160:163], v224 offset:0
    v_add_f32 v246, v246, v32
    v_fma_f32 v36, v36, s26, v244
    v_exp_f32 v35, v35
    v_add_f32 v246, v246, v33
    v_mfma_f32_16x16x32_bf16 v[104:107], v[180:183], v[16:19], v[104:107]
    v_mfma_f32_16x16x32_bf16 v[108:111], v[180:183], v[24:27], v[108:111]
    ds_read_b128 v[164:167], v225 offset:0
    buffer_load_dwordx4 v237, s[4:7], s27 offen offset:1024 nt lds
    v_fma_f32 v37, v37, s26, v244
    v_exp_f32 v36, v36
    v_add_f32 v246, v246, v34
    v_cvt_pk_bf16_f32 v32, v32, v33
    v_mfma_f32_16x16x32_bf16 v[112:115], v[184:187], v[16:19], v[112:115]
    v_mfma_f32_16x16x32_bf16 v[116:119], v[184:187], v[24:27], v[116:119]
    ds_read_b128 v[168:171], v226 offset:0
    v_fma_f32 v38, v38, s26, v244
    v_exp_f32 v37, v37
    v_add_f32 v246, v246, v35
    v_fma_f32 v39, v39, s26, v244
    v_exp_f32 v38, v38
    v_mfma_f32_16x16x32_bf16 v[120:123], v[188:191], v[16:19], v[120:123]
    v_mfma_f32_16x16x32_bf16 v[124:127], v[188:191], v[24:27], v[124:127]
    ds_read_b128 v[172:175], v227 offset:0
    v_add_f32 v246, v246, v36
    v_cvt_pk_bf16_f32 v33, v34, v35
    v_exp_f32 v39, v39
    v_add_f32 v246, v246, v37
    s_waitcnt lgkmcnt(3)
    v_mfma_f32_16x16x32_bf16 v[0:3], v[160:163], v[128:131], 0
    v_mfma_f32_16x16x32_bf16 v[8:11], v[160:163], v[144:147], 0
    ds_read_b128 v[176:179], v224 offset:4096
    v_add_f32 v246, v246, v38
    v_cvt_pk_bf16_f32 v34, v36, v37
    v_add_f32 v246, v246, v39
    v_cvt_pk_bf16_f32 v35, v38, v39
    v_fma_f32 v40, v40, s26, v245
    s_waitcnt lgkmcnt(3)
    v_mfma_f32_16x16x32_bf16 v[0:3], v[164:167], v[132:135], v[0:3]
    v_mfma_f32_16x16x32_bf16 v[8:11], v[164:167], v[148:151], v[8:11]
    ds_read_b128 v[180:183], v225 offset:4096
    s_add_u32 m0, s22, 49152
    s_add_u32 s27, s21, 49152
    buffer_load_dwordx4 v236, s[4:7], s27 offen nt lds
    v_fma_f32 v41, v41, s26, v245
    v_exp_f32 v40, v40
    v_fma_f32 v42, v42, s26, v245
    v_exp_f32 v41, v41
    s_waitcnt lgkmcnt(3)
    v_mfma_f32_16x16x32_bf16 v[0:3], v[168:171], v[136:139], v[0:3]
    v_mfma_f32_16x16x32_bf16 v[8:11], v[168:171], v[152:155], v[8:11]
    ds_read_b128 v[184:187], v226 offset:4096
    v_fma_f32 v43, v43, s26, v245
    v_exp_f32 v42, v42
    v_add_f32 v247, v247, v40
    v_fma_f32 v44, v44, s26, v245
    v_xor_b32 v228, 0x10000, v228
    s_waitcnt lgkmcnt(3)
    v_mfma_f32_16x16x32_bf16 v[0:3], v[172:175], v[140:143], v[0:3]
    v_mfma_f32_16x16x32_bf16 v[8:11], v[172:175], v[156:159], v[8:11]
    ds_read_b128 v[188:191], v227 offset:4096
    v_exp_f32 v43, v43
    v_add_f32 v247, v247, v41
    v_fma_f32 v45, v45, s26, v245
    v_exp_f32 v44, v44
    v_add_f32 v247, v247, v42
    v_xor_b32 v229, 0x10000, v229
    s_waitcnt lgkmcnt(3)
    v_mfma_f32_16x16x32_bf16 v[4:7], v[176:179], v[128:131], 0
    v_mfma_f32_16x16x32_bf16 v[12:15], v[176:179], v[144:147], 0
    ds_read_b128 v[160:163], v224 offset:8192
    v_cvt_pk_bf16_f32 v40, v40, v41
    v_fma_f32 v46, v46, s26, v245
    v_exp_f32 v45, v45
    v_add_f32 v247, v247, v43
    v_xor_b32 v230, 0x10000, v230
    s_waitcnt lgkmcnt(3)
    v_mfma_f32_16x16x32_bf16 v[4:7], v[180:183], v[132:135], v[4:7]
    v_mfma_f32_16x16x32_bf16 v[12:15], v[180:183], v[148:151], v[12:15]
    ds_read_b128 v[164:167], v225 offset:8192
    buffer_load_dwordx4 v237, s[4:7], s27 offen offset:1024 nt lds
    v_fma_f32 v47, v47, s26, v245
    v_exp_f32 v46, v46
    v_add_f32 v247, v247, v44
    v_cvt_pk_bf16_f32 v41, v42, v43
    v_exp_f32 v47, v47
    v_xor_b32 v231, 0x10000, v231
    s_waitcnt lgkmcnt(3)
    v_mfma_f32_16x16x32_bf16 v[4:7], v[184:187], v[136:139], v[4:7]
    v_mfma_f32_16x16x32_bf16 v[12:15], v[184:187], v[152:155], v[12:15]
    ds_read_b128 v[168:171], v226 offset:8192
    v_add_f32 v247, v247, v45
    v_add_f32 v247, v247, v46
    v_cvt_pk_bf16_f32 v42, v44, v45
    v_add_f32 v247, v247, v47
    v_xor_b32 v232, 0x10000, v232
    s_waitcnt lgkmcnt(3)
    v_mfma_f32_16x16x32_bf16 v[4:7], v[188:191], v[140:143], v[4:7]
    v_mfma_f32_16x16x32_bf16 v[12:15], v[188:191], v[156:159], v[12:15]
    ds_read_b128 v[172:175], v227 offset:8192
    v_cvt_pk_bf16_f32 v43, v46, v47
    v_fma_f32 v48, v48, s26, v244
    v_fma_f32 v49, v49, s26, v244
    v_exp_f32 v48, v48
    v_xor_b32 v233, 0x10000, v233
    s_waitcnt lgkmcnt(3)
    v_mfma_f32_16x16x32_bf16 v[16:19], v[160:163], v[128:131], 0
    v_mfma_f32_16x16x32_bf16 v[24:27], v[160:163], v[144:147], 0
    ds_read_b128 v[176:179], v224 offset:12288
    v_fma_f32 v50, v50, s26, v244
    v_exp_f32 v49, v49
    v_fma_f32 v51, v51, s26, v244
    v_exp_f32 v50, v50
    v_add_f32 v246, v246, v48
    v_xor_b32 v234, 0x10000, v234
    s_waitcnt lgkmcnt(3)
    v_mfma_f32_16x16x32_bf16 v[16:19], v[164:167], v[132:135], v[16:19]
    v_mfma_f32_16x16x32_bf16 v[24:27], v[164:167], v[148:151], v[24:27]
    ds_read_b128 v[180:183], v225 offset:12288
    buffer_store_dwordx4 v[192:195], v241, s[16:19], s33 offen sc1
    v_fma_f32 v52, v52, s26, v244
    v_exp_f32 v51, v51
    v_add_f32 v246, v246, v49
    v_fma_f32 v53, v53, s26, v244
    v_xor_b32 v235, 0x10000, v235
    s_waitcnt lgkmcnt(3)
    v_mfma_f32_16x16x32_bf16 v[16:19], v[168:171], v[136:139], v[16:19]
    v_mfma_f32_16x16x32_bf16 v[24:27], v[168:171], v[152:155], v[24:27]
    ds_read_b128 v[184:187], v226 offset:12288
    v_exp_f32 v52, v52
    v_add_f32 v246, v246, v50
    v_cvt_pk_bf16_f32 v48, v48, v49
    v_fma_f32 v54, v54, s26, v244
    v_exp_f32 v53, v53
    s_waitcnt lgkmcnt(3)
    v_mfma_f32_16x16x32_bf16 v[16:19], v[172:175], v[140:143], v[16:19]
    v_mfma_f32_16x16x32_bf16 v[24:27], v[172:175], v[156:159], v[24:27]
    ds_read_b128 v[188:191], v227 offset:12288
    v_add_f32 v246, v246, v51
    v_fma_f32 v55, v55, s26, v244
    v_exp_f32 v54, v54
    v_add_f32 v246, v246, v52
    s_waitcnt lgkmcnt(3)
    v_mfma_f32_16x16x32_bf16 v[20:23], v[176:179], v[128:131], 0
    v_mfma_f32_16x16x32_bf16 v[28:31], v[176:179], v[144:147], 0
    s_waitcnt vmcnt(13) lgkmcnt(0)
    s_barrier
    ds_read_b64_tr_b16 v[160:161], v228 offset:16384
    ds_read_b64_tr_b16 v[162:163], v228 offset:20480
    v_cvt_pk_bf16_f32 v49, v50, v51
    v_exp_f32 v55, v55
    v_add_f32 v246, v246, v53
    v_add_f32 v246, v246, v54
    v_mfma_f32_16x16x32_bf16 v[20:23], v[180:183], v[132:135], v[20:23]
    v_mfma_f32_16x16x32_bf16 v[28:31], v[180:183], v[148:151], v[28:31]
    ds_read_b64_tr_b16 v[164:165], v229 offset:16384
    ds_read_b64_tr_b16 v[166:167], v229 offset:20480
    buffer_store_dwordx4 v[196:199], v253, s[16:19], s33 offen offset:1024 sc1
    v_cvt_pk_bf16_f32 v50, v52, v53
    v_add_f32 v246, v246, v55
    v_cvt_pk_bf16_f32 v51, v54, v55
    v_max_f32 v242, v0, v1
    v_max_f32 v243, v8, v9
    v_mfma_f32_16x16x32_bf16 v[20:23], v[184:187], v[136:139], v[20:23]
    v_mfma_f32_16x16x32_bf16 v[28:31], v[184:187], v[152:155], v[28:31]
    ds_read_b64_tr_b16 v[168:169], v230 offset:16384
    ds_read_b64_tr_b16 v[170:171], v230 offset:20480
    v_max3_f32 v242, v242, v2, v3
    v_max3_f32 v243, v243, v10, v11
    v_max3_f32 v242, v242, v4, v5
    v_max3_f32 v243, v243, v12, v13
    v_mfma_f32_16x16x32_bf16 v[20:23], v[188:191], v[140:143], v[20:23]
    v_mfma_f32_16x16x32_bf16 v[28:31], v[188:191], v[156:159], v[28:31]
    ds_read_b64_tr_b16 v[172:173], v231 offset:16384
    ds_read_b64_tr_b16 v[174:175], v231 offset:20480
    v_max3_f32 v242, v242, v6, v7
    v_max3_f32 v243, v243, v14, v15
    v_fma_f32 v56, v56, s26, v245
    v_fma_f32 v57, v57, s26, v245
    v_exp_f32 v56, v56
    s_waitcnt lgkmcnt(6)
    v_mfma_f32_16x16x32_bf16 v[64:67], v[160:163], v[32:35], v[64:67]
    v_mfma_f32_16x16x32_bf16 v[68:71], v[160:163], v[40:43], v[68:71]
    ds_read_b64_tr_b16 v[176:177], v232 offset:16384
    ds_read_b64_tr_b16 v[178:179], v232 offset:20480
    v_fma_f32 v58, v58, s26, v245
    v_exp_f32 v57, v57
    v_fma_f32 v59, v59, s26, v245
    v_exp_f32 v58, v58
    s_waitcnt lgkmcnt(6)
    v_mfma_f32_16x16x32_bf16 v[72:75], v[164:167], v[32:35], v[72:75]
    v_mfma_f32_16x16x32_bf16 v[76:79], v[164:167], v[40:43], v[76:79]
    ds_read_b64_tr_b16 v[180:181], v233 offset:16384
    ds_read_b64_tr_b16 v[182:183], v233 offset:20480
    s_mov_b32 m0, s23
    s_nop 0
    buffer_load_dwordx4 v236, s[8:11], s21 offen nt lds
    v_add_f32 v247, v247, v56
    v_fma_f32 v60, v60, s26, v245
    v_exp_f32 v59, v59
    v_add_f32 v247, v247, v57
    s_waitcnt lgkmcnt(6)
    v_mfma_f32_16x16x32_bf16 v[80:83], v[168:171], v[32:35], v[80:83]
    v_mfma_f32_16x16x32_bf16 v[84:87], v[168:171], v[40:43], v[84:87]
    ds_read_b64_tr_b16 v[184:185], v234 offset:16384
    ds_read_b64_tr_b16 v[186:187], v234 offset:20480
    v_fma_f32 v61, v61, s26, v245
    v_exp_f32 v60, v60
    v_add_f32 v247, v247, v58
    v_cvt_pk_bf16_f32 v56, v56, v57
    v_fma_f32 v62, v62, s26, v245
    s_waitcnt lgkmcnt(6)
    v_mfma_f32_16x16x32_bf16 v[88:91], v[172:175], v[32:35], v[88:91]
    v_mfma_f32_16x16x32_bf16 v[92:95], v[172:175], v[40:43], v[92:95]
    ds_read_b64_tr_b16 v[188:189], v235 offset:16384
    ds_read_b64_tr_b16 v[190:191], v235 offset:20480
    v_exp_f32 v61, v61
    v_add_f32 v247, v247, v59
    v_fma_f32 v63, v63, s26, v245
    v_exp_f32 v62, v62
    s_waitcnt lgkmcnt(6)
    v_mfma_f32_16x16x32_bf16 v[96:99], v[176:179], v[32:35], v[96:99]
    v_mfma_f32_16x16x32_bf16 v[100:103], v[176:179], v[40:43], v[100:103]
    ds_read_b64_tr_b16 v[160:161], v228 offset:24576
    ds_read_b64_tr_b16 v[162:163], v228 offset:28672
    v_add_f32 v247, v247, v60
    v_cvt_pk_bf16_f32 v57, v58, v59
    v_exp_f32 v63, v63
    v_add_f32 v247, v247, v61
    v_add_f32 v247, v247, v62
    s_waitcnt lgkmcnt(6)
    v_mfma_f32_16x16x32_bf16 v[104:107], v[180:183], v[32:35], v[104:107]
    v_mfma_f32_16x16x32_bf16 v[108:111], v[180:183], v[40:43], v[108:111]
    ds_read_b64_tr_b16 v[164:165], v229 offset:24576
    ds_read_b64_tr_b16 v[166:167], v229 offset:28672
    buffer_load_dwordx4 v237, s[8:11], s21 offen offset:1024 nt lds
    v_cvt_pk_bf16_f32 v58, v60, v61
    v_add_f32 v247, v247, v63
    v_cvt_pk_bf16_f32 v59, v62, v63
    v_max3_f32 v242, v242, v16, v17
    s_waitcnt lgkmcnt(6)
    v_mfma_f32_16x16x32_bf16 v[112:115], v[184:187], v[32:35], v[112:115]
    v_mfma_f32_16x16x32_bf16 v[116:119], v[184:187], v[40:43], v[116:119]
    ds_read_b64_tr_b16 v[168:169], v230 offset:24576
    ds_read_b64_tr_b16 v[170:171], v230 offset:28672
    v_max3_f32 v243, v243, v24, v25
    v_max3_f32 v242, v242, v18, v19
    v_max3_f32 v243, v243, v26, v27
    v_max3_f32 v242, v242, v20, v21
    s_waitcnt lgkmcnt(6)
    v_mfma_f32_16x16x32_bf16 v[120:123], v[188:191], v[32:35], v[120:123]
    v_mfma_f32_16x16x32_bf16 v[124:127], v[188:191], v[40:43], v[124:127]
    ds_read_b64_tr_b16 v[172:173], v231 offset:24576
    ds_read_b64_tr_b16 v[174:175], v231 offset:28672
    v_max3_f32 v243, v243, v28, v29
    v_max3_f32 v242, v242, v22, v23
    v_max3_f32 v243, v243, v30, v31
    v_fma_f32 v250, v242, s26, v244
    v_fma_f32 v251, v243, s26, v245
    s_waitcnt lgkmcnt(6)
    v_mfma_f32_16x16x32_bf16 v[64:67], v[160:163], v[48:51], v[64:67]
    v_mfma_f32_16x16x32_bf16 v[68:71], v[160:163], v[56:59], v[68:71]
    ds_read_b64_tr_b16 v[176:177], v232 offset:24576
    ds_read_b64_tr_b16 v[178:179], v232 offset:28672
    v_max_f32 v250, v250, v251
    v_cmp_lt_f32 vcc, s35, v250
    s_cbranch_vccnz L_rareF2
L_backF2:
    v_fma_f32 v0, v0, s26, v244
    v_fma_f32 v1, v1, s26, v244
    s_waitcnt lgkmcnt(6)
    v_mfma_f32_16x16x32_bf16 v[72:75], v[164:167], v[48:51], v[72:75]
    v_mfma_f32_16x16x32_bf16 v[76:79], v[164:167], v[56:59], v[76:79]
    ds_read_b64_tr_b16 v[180:181], v233 offset:24576
    ds_read_b64_tr_b16 v[182:183], v233 offset:28672
    buffer_store_dwordx4 v[200:203], v241, s[16:19], s33 offen offset:2048 sc1
    v_exp_f32 v0, v0
    v_fma_f32 v2, v2, s26, v244
    v_exp_f32 v1, v1
    v_fma_f32 v3, v3, s26, v244
    v_exp_f32 v2, v2
    s_waitcnt lgkmcnt(6)
    v_mfma_f32_16x16x32_bf16 v[80:83], v[168:171], v[48:51], v[80:83]
    v_mfma_f32_16x16x32_bf16 v[84:87], v[168:171], v[56:59], v[84:87]
    ds_read_b64_tr_b16 v[184:185], v234 offset:24576
    ds_read_b64_tr_b16 v[186:187], v234 offset:28672
    v_add_f32 v246, v246, v0
    v_fma_f32 v4, v4, s26, v244
    v_exp_f32 v3, v3
    v_add_f32 v246, v246, v1
    s_waitcnt lgkmcnt(6)
    v_mfma_f32_16x16x32_bf16 v[88:91], v[172:175], v[48:51], v[88:91]
    v_mfma_f32_16x16x32_bf16 v[92:95], v[172:175], v[56:59], v[92:95]
    ds_read_b64_tr_b16 v[188:189], v235 offset:24576
    ds_read_b64_tr_b16 v[190:191], v235 offset:28672
    v_fma_f32 v5, v5, s26, v244
    v_exp_f32 v4, v4
    v_add_f32 v246, v246, v2
    v_cvt_pk_bf16_f32 v0, v0, v1
    s_waitcnt lgkmcnt(6)
    v_mfma_f32_16x16x32_bf16 v[96:99], v[176:179], v[48:51], v[96:99]
    v_mfma_f32_16x16x32_bf16 v[100:103], v[176:179], v[56:59], v[100:103]
    s_waitcnt vmcnt(13) lgkmcnt(0)
    s_barrier
    ds_read_b128 v[160:163], v224 offset:32768
    v_fma_f32 v6, v6, s26, v244
    v_exp_f32 v5, v5
    v_add_f32 v246, v246, v3
    v_fma_f32 v7, v7, s26, v244
    v_exp_f32 v6, v6
    v_mfma_f32_16x16x32_bf16 v[104:107], v[180:183], v[48:51], v[104:107]
    v_mfma_f32_16x16x32_bf16 v[108:111], v[180:183], v[56:59], v[108:111]
    ds_read_b128 v[164:167], v225 offset:32768
    buffer_store_dwordx4 v[204:207], v253, s[16:19], s33 offen offset:3072 sc1
    v_add_f32 v246, v246, v4
    v_cvt_pk_bf16_f32 v1, v2, v3
    v_exp_f32 v7, v7
    v_add_f32 v246, v246, v5
    v_mfma_f32_16x16x32_bf16 v[112:115], v[184:187], v[48:51], v[112:115]
    v_mfma_f32_16x16x32_bf16 v[116:119], v[184:187], v[56:59], v[116:119]
    ds_read_b128 v[168:171], v226 offset:32768
    v_add_f32 v246, v246, v6
    v_cvt_pk_bf16_f32 v2, v4, v5
    v_add_f32 v246, v246, v7
    v_cvt_pk_bf16_f32 v3, v6, v7
    v_fma_f32 v8, v8, s26, v245
    v_mfma_f32_16x16x32_bf16 v[120:123], v[188:191], v[48:51], v[120:123]
    v_mfma_f32_16x16x32_bf16 v[124:127], v[188:191], v[56:59], v[124:127]
    ds_read_b128 v[172:175], v227 offset:32768
    v_fma_f32 v9, v9, s26, v245
    v_exp_f32 v8, v8
    v_fma_f32 v10, v10, s26, v245
    v_exp_f32 v9, v9
    s_waitcnt lgkmcnt(3)
    v_mfma_f32_16x16x32_bf16 v[32:35], v[160:163], v[128:131], 0
    v_mfma_f32_16x16x32_bf16 v[40:43], v[160:163], v[144:147], 0
    ds_read_b128 v[176:179], v224 offset:36864
    v_fma_f32 v11, v11, s26, v245
    v_exp_f32 v10, v10
    v_add_f32 v247, v247, v8
    v_fma_f32 v12, v12, s26, v245
    s_waitcnt lgkmcnt(3)
    v_mfma_f32_16x16x32_bf16 v[32:35], v[164:167], v[132:135], v[32:35]
    v_mfma_f32_16x16x32_bf16 v[40:43], v[164:167], v[148:151], v[40:43]
    ds_read_b128 v[180:183], v225 offset:36864
    s_add_u32 m0, s23, 16384
    s_add_u32 s27, s20, 49152
    buffer_load_dwordx4 v238, s[12:15], s27 offen nt lds
    v_exp_f32 v11, v11
    v_add_f32 v247, v247, v9
    v_fma_f32 v13, v13, s26, v245
    v_exp_f32 v12, v12
    v_add_f32 v247, v247, v10
    s_waitcnt lgkmcnt(3)
    v_mfma_f32_16x16x32_bf16 v[32:35], v[168:171], v[136:139], v[32:35]
    v_mfma_f32_16x16x32_bf16 v[40:43], v[168:171], v[152:155], v[40:43]
    ds_read_b128 v[184:187], v226 offset:36864
    v_cvt_pk_bf16_f32 v8, v8, v9
    v_fma_f32 v14, v14, s26, v245
    v_exp_f32 v13, v13
    v_add_f32 v247, v247, v11
    s_waitcnt lgkmcnt(3)
    v_mfma_f32_16x16x32_bf16 v[32:35], v[172:175], v[140:143], v[32:35]
    v_mfma_f32_16x16x32_bf16 v[40:43], v[172:175], v[156:159], v[40:43]
    ds_read_b128 v[188:191], v227 offset:36864
    v_fma_f32 v15, v15, s26, v245
    v_exp_f32 v14, v14
    v_add_f32 v247, v247, v12
    v_cvt_pk_bf16_f32 v9, v10, v11
    v_exp_f32 v15, v15
    s_waitcnt lgkmcnt(3)
    v_mfma_f32_16x16x32_bf16 v[36:39], v[176:179], v[128:131], 0
    v_mfma_f32_16x16x32_bf16 v[44:47], v[176:179], v[144:147], 0
    ds_read_b128 v[160:163], v224 offset:40960
    v_add_f32 v247, v247, v13
    v_add_f32 v247, v247, v14
    v_cvt_pk_bf16_f32 v10, v12, v13
    v_add_f32 v247, v247, v15
    s_waitcnt lgkmcnt(3)
    v_mfma_f32_16x16x32_bf16 v[36:39], v[180:183], v[132:135], v[36:39]
    v_mfma_f32_16x16x32_bf16 v[44:47], v[180:183], v[148:151], v[44:47]
    ds_read_b128 v[164:167], v225 offset:40960
    buffer_load_dwordx4 v239, s[12:15], s27 offen offset:1024 nt lds
    v_cvt_pk_bf16_f32 v11, v14, v15
    v_fma_f32 v16, v16, s26, v244
    v_fma_f32 v17, v17, s26, v244
    v_exp_f32 v16, v16
    s_waitcnt lgkmcnt(3)
    v_mfma_f32_16x16x32_bf16 v[36:39], v[184:187], v[136:139], v[36:39]
    v_mfma_f32_16x16x32_bf16 v[44:47], v[184:187], v[152:155], v[44:47]
    ds_read_b128 v[168:171], v226 offset:40960
    v_fma_f32 v18, v18, s26, v244
    v_exp_f32 v17, v17
    v_fma_f32 v19, v19, s26, v244
    v_exp_f32 v18, v18
    v_add_f32 v246, v246, v16
    s_waitcnt lgkmcnt(3)
    v_mfma_f32_16x16x32_bf16 v[36:39], v[188:191], v[140:143], v[36:39]
    v_mfma_f32_16x16x32_bf16 v[44:47], v[188:191], v[156:159], v[44:47]
    ds_read_b128 v[172:175], v227 offset:40960
    v_fma_f32 v20, v20, s26, v244
    v_exp_f32 v19, v19
    v_add_f32 v246, v246, v17
    v_fma_f32 v21, v21, s26, v244
    s_waitcnt lgkmcnt(3)
    v_mfma_f32_16x16x32_bf16 v[48:51], v[160:163], v[128:131], 0
    v_mfma_f32_16x16x32_bf16 v[56:59], v[160:163], v[144:147], 0
    ds_read_b128 v[176:179], v224 offset:45056
    v_exp_f32 v20, v20
    v_add_f32 v246, v246, v18
    v_cvt_pk_bf16_f32 v16, v16, v17
    v_fma_f32 v22, v22, s26, v244
    v_exp_f32 v21, v21
    s_waitcnt lgkmcnt(3)
    v_mfma_f32_16x16x32_bf16 v[48:51], v[164:167], v[132:135], v[48:51]
    v_mfma_f32_16x16x32_bf16 v[56:59], v[164:167], v[148:151], v[56:59]
    ds_read_b128 v[180:183], v225 offset:45056
    buffer_store_dwordx4 v[208:211], v241, s[16:19], s34 offen sc1
    v_add_f32 v246, v246, v19
    v_fma_f32 v23, v23, s26, v244
    v_exp_f32 v22, v22
    v_add_f32 v246, v246, v20
    s_waitcnt lgkmcnt(3)
    v_mfma_f32_16x16x32_bf16 v[48:51], v[168:171], v[136:139], v[48:51]
    v_mfma_f32_16x16x32_bf16 v[56:59], v[168:171], v[152:155], v[56:59]
    ds_read_b128 v[184:187], v226 offset:45056
    v_cvt_pk_bf16_f32 v17, v18, v19
    v_exp_f32 v23, v23
    v_add_f32 v246, v246, v21
    v_add_f32 v246, v246, v22
    s_waitcnt lgkmcnt(3)
    v_mfma_f32_16x16x32_bf16 v[48:51], v[172:175], v[140:143], v[48:51]
    v_mfma_f32_16x16x32_bf16 v[56:59], v[172:175], v[156:159], v[56:59]
    ds_read_b128 v[188:191], v227 offset:45056
    v_cvt_pk_bf16_f32 v18, v20, v21
    v_add_f32 v246, v246, v23
    v_cvt_pk_bf16_f32 v19, v22, v23
    v_max_f32 v242, v32, v33
    v_max_f32 v243, v40, v41
    s_waitcnt lgkmcnt(3)
    v_mfma_f32_16x16x32_bf16 v[52:55], v[176:179], v[128:131], 0
    v_mfma_f32_16x16x32_bf16 v[60:63], v[176:179], v[144:147], 0
    s_waitcnt vmcnt(9) lgkmcnt(0)
    s_barrier
    ds_read_b64_tr_b16 v[160:161], v228 offset:49152
    ds_read_b64_tr_b16 v[162:163], v228 offset:53248
    v_max3_f32 v242, v242, v34, v35
    v_max3_f32 v243, v243, v42, v43
    v_max3_f32 v242, v242, v36, v37
    v_max3_f32 v243, v243, v44, v45
    v_mfma_f32_16x16x32_bf16 v[52:55], v[180:183], v[132:135], v[52:55]
    v_mfma_f32_16x16x32_bf16 v[60:63], v[180:183], v[148:151], v[60:63]
    ds_read_b64_tr_b16 v[164:165], v229 offset:49152
    ds_read_b64_tr_b16 v[166:167], v229 offset:53248
    buffer_store_dwordx4 v[212:215], v253, s[16:19], s34 offen offset:1024 sc1
    v_max3_f32 v242, v242, v38, v39
    v_max3_f32 v243, v243, v46, v47
    v_fma_f32 v24, v24, s26, v245
    v_fma_f32 v25, v25, s26, v245
    v_exp_f32 v24, v24
    v_mfma_f32_16x16x32_bf16 v[52:55], v[184:187], v[136:139], v[52:55]
    v_mfma_f32_16x16x32_bf16 v[60:63], v[184:187], v[152:155], v[60:63]
    ds_read_b64_tr_b16 v[168:169], v230 offset:49152
    ds_read_b64_tr_b16 v[170:171], v230 offset:53248
    v_fma_f32 v26, v26, s26, v245
    v_exp_f32 v25, v25
    v_fma_f32 v27, v27, s26, v245
    v_exp_f32 v26, v26
    s_add_u32 s46, s21, 16777216
    v_mfma_f32_16x16x32_bf16 v[52:55], v[188:191], v[140:143], v[52:55]
    v_mfma_f32_16x16x32_bf16 v[60:63], v[188:191], v[156:159], v[60:63]
    ds_read_b64_tr_b16 v[172:173], v231 offset:49152
    ds_read_b64_tr_b16 v[174:175], v231 offset:53248
    v_add_f32 v247, v247, v24
    v_fma_f32 v28, v28, s26, v245
    v_exp_f32 v27, v27
    v_add_f32 v247, v247, v25
    s_waitcnt lgkmcnt(6)
    v_mfma_f32_16x16x32_bf16 v[64:67], v[160:163], v[0:3], v[64:67]
    v_mfma_f32_16x16x32_bf16 v[68:71], v[160:163], v[8:11], v[68:71]
    ds_read_b64_tr_b16 v[176:177], v232 offset:49152
    ds_read_b64_tr_b16 v[178:179], v232 offset:53248
    v_fma_f32 v29, v29, s26, v245
    v_exp_f32 v28, v28
    v_add_f32 v247, v247, v26
    v_cvt_pk_bf16_f32 v24, v24, v25
    v_fma_f32 v30, v30, s26, v245
    s_waitcnt lgkmcnt(6)
    v_mfma_f32_16x16x32_bf16 v[72:75], v[164:167], v[0:3], v[72:75]
    v_mfma_f32_16x16x32_bf16 v[76:79], v[164:167], v[8:11], v[76:79]
    ds_read_b64_tr_b16 v[180:181], v233 offset:49152
    ds_read_b64_tr_b16 v[182:183], v233 offset:53248
    s_add_u32 m0, s23, 32768
    s_add_u32 s27, s21, 16384
    buffer_load_dwordx4 v236, s[8:11], s27 offen nt lds
    v_exp_f32 v29, v29
    v_add_f32 v247, v247, v27
    v_fma_f32 v31, v31, s26, v245
    v_exp_f32 v30, v30
    v_add_u32 v192, s24, v224
    s_waitcnt lgkmcnt(6)
    v_mfma_f32_16x16x32_bf16 v[80:83], v[168:171], v[0:3], v[80:83]
    v_mfma_f32_16x16x32_bf16 v[84:87], v[168:171], v[8:11], v[84:87]
    ds_read_b64_tr_b16 v[184:185], v234 offset:49152
    ds_read_b64_tr_b16 v[186:187], v234 offset:53248
    v_add_f32 v247, v247, v28
    v_cvt_pk_bf16_f32 v25, v26, v27
    v_exp_f32 v31, v31
    v_add_f32 v247, v247, v29
    v_add_f32 v247, v247, v30
    v_add_u32 v193, s24, v225
    ds_read_b128 v[128:131], v192 offset:0
    s_waitcnt lgkmcnt(7)
    v_mfma_f32_16x16x32_bf16 v[88:91], v[172:175], v[0:3], v[88:91]
    v_mfma_f32_16x16x32_bf16 v[92:95], v[172:175], v[8:11], v[92:95]
    ds_read_b64_tr_b16 v[188:189], v235 offset:49152
    ds_read_b64_tr_b16 v[190:191], v235 offset:53248
    v_cvt_pk_bf16_f32 v26, v28, v29
    v_add_f32 v247, v247, v31
    v_cvt_pk_bf16_f32 v27, v30, v31
    v_max3_f32 v242, v242, v48, v49
    v_add_u32 v194, s24, v226
    ds_read_b128 v[132:135], v193 offset:0
    s_waitcnt lgkmcnt(8)
    v_mfma_f32_16x16x32_bf16 v[96:99], v[176:179], v[0:3], v[96:99]
    v_mfma_f32_16x16x32_bf16 v[100:103], v[176:179], v[8:11], v[100:103]
    ds_read_b64_tr_b16 v[160:161], v228 offset:57344
    ds_read_b64_tr_b16 v[162:163], v228 offset:61440
    v_max3_f32 v243, v243, v56, v57
    v_max3_f32 v242, v242, v50, v51
    v_max3_f32 v243, v243, v58, v59
    v_max3_f32 v242, v242, v52, v53
    v_add_u32 v195, s24, v227
    ds_read_b128 v[136:139], v194 offset:0
    s_waitcnt lgkmcnt(9)
    v_mfma_f32_16x16x32_bf16 v[104:107], v[180:183], v[0:3], v[104:107]
    v_mfma_f32_16x16x32_bf16 v[108:111], v[180:183], v[8:11], v[108:111]
    ds_read_b64_tr_b16 v[164:165], v229 offset:57344
    ds_read_b64_tr_b16 v[166:167], v229 offset:61440
    buffer_load_dwordx4 v237, s[8:11], s27 offen offset:1024 nt lds
    v_max3_f32 v243, v243, v60, v61
    v_max3_f32 v242, v242, v54, v55
    v_max3_f32 v243, v243, v62, v63
    v_fma_f32 v250, v242, s26, v244
    v_fma_f32 v251, v243, s26, v245
    ds_read_b128 v[140:143], v195 offset:0
    s_waitcnt lgkmcnt(10)
    v_mfma_f32_16x16x32_bf16 v[112:115], v[184:187], v[0:3], v[112:115]
    v_mfma_f32_16x16x32_bf16 v[116:119], v[184:187], v[8:11], v[116:119]
    ds_read_b64_tr_b16 v[168:169], v230 offset:57344
    ds_read_b64_tr_b16 v[170:171], v230 offset:61440
    v_max_f32 v250, v250, v251
    v_cmp_lt_f32 vcc, s35, v250
    s_cbranch_vccnz L_rareF3
L_backF3:
    v_fma_f32 v32, v32, s26, v244
    v_fma_f32 v33, v33, s26, v244
    ds_read_b128 v[144:147], v192 offset:4096
    s_waitcnt lgkmcnt(10)
    v_mfma_f32_16x16x32_bf16 v[120:123], v[188:191], v[0:3], v[120:123]
    v_mfma_f32_16x16x32_bf16 v[124:127], v[188:191], v[8:11], v[124:127]
    ds_read_b64_tr_b16 v[172:173], v231 offset:57344
    ds_read_b64_tr_b16 v[174:175], v231 offset:61440
    v_exp_f32 v32, v32
    v_fma_f32 v34, v34, s26, v244
    v_exp_f32 v33, v33
    v_fma_f32 v35, v35, s26, v244
    v_exp_f32 v34, v34
    ds_read_b128 v[148:151], v193 offset:4096
    s_waitcnt lgkmcnt(10)
    v_mfma_f32_16x16x32_bf16 v[64:67], v[160:163], v[16:19], v[64:67]
    v_mfma_f32_16x16x32_bf16 v[68:71], v[160:163], v[24:27], v[68:71]
    ds_read_b64_tr_b16 v[176:177], v232 offset:57344
    ds_read_b64_tr_b16 v[178:179], v232 offset:61440
    v_add_f32 v246, v246, v32
    v_fma_f32 v36, v36, s26, v244
    v_exp_f32 v35, v35
    v_add_f32 v246, v246, v33
    ds_read_b128 v[152:155], v194 offset:4096
    s_waitcnt lgkmcnt(10)
    v_mfma_f32_16x16x32_bf16 v[72:75], v[164:167], v[16:19], v[72:75]
    v_mfma_f32_16x16x32_bf16 v[76:79], v[164:167], v[24:27], v[76:79]
    ds_read_b64_tr_b16 v[180:181], v233 offset:57344
    ds_read_b64_tr_b16 v[182:183], v233 offset:61440
    buffer_store_dwordx4 v[216:219], v241, s[16:19], s34 offen offset:2048 sc1
    v_fma_f32 v37, v37, s26, v244
    v_exp_f32 v36, v36
    v_add_f32 v246, v246, v34
    v_cvt_pk_bf16_f32 v32, v32, v33
    ds_read_b128 v[156:159], v195 offset:4096
    s_waitcnt lgkmcnt(10)
    v_mfma_f32_16x16x32_bf16 v[80:83], v[168:171], v[16:19], v[80:83]
    v_mfma_f32_16x16x32_bf16 v[84:87], v[168:171], v[24:27], v[84:87]
    ds_read_b64_tr_b16 v[184:185], v234 offset:57344
    ds_read_b64_tr_b16 v[186:187], v234 offset:61440
    v_fma_f32 v38, v38, s26, v244
    v_exp_f32 v37, v37
    v_add_f32 v246, v246, v35
    v_fma_f32 v39, v39, s26, v244
    v_exp_f32 v38, v38
    s_waitcnt lgkmcnt(9)
    v_mfma_f32_16x16x32_bf16 v[88:91], v[172:175], v[16:19], v[88:91]
    v_mfma_f32_16x16x32_bf16 v[92:95], v[172:175], v[24:27], v[92:95]
    ds_read_b64_tr_b16 v[188:189], v235 offset:57344
    ds_read_b64_tr_b16 v[190:191], v235 offset:61440
    v_add_f32 v246, v246, v36
    v_cvt_pk_bf16_f32 v33, v34, v35
    v_exp_f32 v39, v39
    v_add_f32 v246, v246, v37
    s_waitcnt lgkmcnt(8)
    v_mfma_f32_16x16x32_bf16 v[96:99], v[176:179], v[16:19], v[96:99]
    v_mfma_f32_16x16x32_bf16 v[100:103], v[176:179], v[24:27], v[100:103]
    s_waitcnt vmcnt(9) lgkmcnt(0)
    s_barrier
    ds_read_b128 v[160:163], v224 offset:0
    v_add_f32 v246, v246, v38
    v_cvt_pk_bf16_f32 v34, v36, v37
    v_add_f32 v246, v246, v39
    v_cvt_pk_bf16_f32 v35, v38, v39
    v_mfma_f32_16x16x32_bf16 v[104:107], v[180:183], v[16:19], v[104:107]
    v_mfma_f32_16x16x32_bf16 v[108:111], v[180:183], v[24:27], v[108:111]
    ds_read_b128 v[164:167], v225 offset:0
    buffer_store_dwordx4 v[220:223], v253, s[16:19], s34 offen offset:3072 sc1
    v_mfma_f32_16x16x32_bf16 v[112:115], v[184:187], v[16:19], v[112:115]
    v_mfma_f32_16x16x32_bf16 v[116:119], v[184:187], v[24:27], v[116:119]
    ds_read_b128 v[168:171], v226 offset:0
    v_mfma_f32_16x16x32_bf16 v[120:123], v[188:191], v[16:19], v[120:123]
    v_mfma_f32_16x16x32_bf16 v[124:127], v[188:191], v[24:27], v[124:127]
    ds_read_b128 v[172:175], v227 offset:0
    s_xor_b32 s22, s22, 0x10000
    s_xor_b32 s23, s23, 0x10000
    s_sub_u32 s24, s32, s24
    s_mov_b32 s33, s20
    s_add_u32 s34, s20, 4096
    s_mov_b32 s18, s29
    s_mov_b32 s20, s21
    s_mov_b32 s21, s46
L_loop:
    s_waitcnt lgkmcnt(3)
    v_mfma_f32_16x16x32_bf16 v[0:3], v[160:163], v[128:131], 0
    v_mfma_f32_16x16x32_bf16 v[8:11], v[160:163], v[144:147], 0
    ds_read_b128 v[176:179], v224 offset:4096
    v_fma_f32 v40, v40, s26, v245
    v_fma_f32 v41, v41, s26, v245
    v_exp_f32 v40, v40
    v_fma_f32 v42, v42, s26, v245
    v_exp_f32 v41, v41
    s_waitcnt lgkmcnt(3)
    v_mfma_f32_16x16x32_bf16 v[0:3], v[164:167], v[132:135], v[0:3]
    v_mfma_f32_16x16x32_bf16 v[8:11], v[164:167], v[148:151], v[8:11]
    ds_read_b128 v[180:183], v225 offset:4096
    s_add_u32 m0, s22, 49152
    s_nop 0
    buffer_load_dwordx4 v238, s[12:15], s20 offen nt lds
    v_fma_f32 v43, v43, s26, v245
    v_exp_f32 v42, v42
    v_add_f32 v247, v247, v40
    v_fma_f32 v44, v44, s26, v245
    v_exp_f32 v43, v43
    s_waitcnt lgkmcnt(3)
    v_mfma_f32_16x16x32_bf16 v[0:3], v[168:171], v[136:139], v[0:3]
    v_mfma_f32_16x16x32_bf16 v[8:11], v[168:171], v[152:155], v[8:11]
    ds_read_b128 v[184:187], v226 offset:4096
    v_add_f32 v247, v247, v41
    v_fma_f32 v45, v45, s26, v245
    v_exp_f32 v44, v44
    v_add_f32 v247, v247, v42
    v_cvt_pk_bf16_f32 v40, v40, v41
    s_waitcnt lgkmcnt(3)
    v_mfma_f32_16x16x32_bf16 v[0:3], v[172:175], v[140:143], v[0:3]
    v_mfma_f32_16x16x32_bf16 v[8:11], v[172:175], v[156:159], v[8:11]
    ds_read_b128 v[188:191], v227 offset:4096
    v_fma_f32 v46, v46, s26, v245
    v_exp_f32 v45, v45
    v_add_f32 v247, v247, v43
    v_fma_f32 v47, v47, s26, v245
    v_exp_f32 v46, v46
    v_add_f32 v247, v247, v44
    s_waitcnt lgkmcnt(3)
    v_mfma_f32_16x16x32_bf16 v[4:7], v[176:179], v[128:131], 0
    v_mfma_f32_16x16x32_bf16 v[12:15], v[176:179], v[144:147], 0
    ds_read_b128 v[160:163], v224 offset:8192
    v_cvt_pk_bf16_f32 v41, v42, v43
    v_exp_f32 v47, v47
    v_add_f32 v247, v247, v45
    v_add_f32 v247, v247, v46
    v_cvt_pk_bf16_f32 v42, v44, v45
    s_waitcnt lgkmcnt(3)
    v_mfma_f32_16x16x32_bf16 v[4:7], v[180:183], v[132:135], v[4:7]
    v_mfma_f32_16x16x32_bf16 v[12:15], v[180:183], v[148:151], v[12:15]
    ds_read_b128 v[164:167], v225 offset:8192
    buffer_load_dwordx4 v239, s[12:15], s20 offen offset:1024 nt lds
    v_add_f32 v247, v247, v47
    v_cvt_pk_bf16_f32 v43, v46, v47
    v_fma_f32 v48, v48, s26, v244
    v_fma_f32 v49, v49, s26, v244
    v_exp_f32 v48, v48
    s_waitcnt lgkmcnt(3)
    v_mfma_f32_16x16x32_bf16 v[4:7], v[184:187], v[136:139], v[4:7]
    v_mfma_f32_16x16x32_bf16 v[12:15], v[184:187], v[152:155], v[12:15]
    ds_read_b128 v[168:171], v226 offset:8192
    v_fma_f32 v50, v50, s26, v244
    v_exp_f32 v49, v49
    v_fma_f32 v51, v51, s26, v244
    v_exp_f32 v50, v50
    v_add_f32 v246, v246, v48
    v_fma_f32 v52, v52, s26, v244
    s_waitcnt lgkmcnt(3)
    v_mfma_f32_16x16x32_bf16 v[4:7], v[188:191], v[140:143], v[4:7]
    v_mfma_f32_16x16x32_bf16 v[12:15], v[188:191], v[156:159], v[12:15]
    ds_read_b128 v[172:175], v227 offset:8192
    v_exp_f32 v51, v51
    v_add_f32 v246, v246, v49
    v_fma_f32 v53, v53, s26, v244
    v_exp_f32 v52, v52
    v_add_f32 v246, v246, v50
    s_waitcnt lgkmcnt(3)
    v_mfma_f32_16x16x32_bf16 v[16:19], v[160:163], v[128:131], 0
    v_mfma_f32_16x16x32_bf16 v[24:27], v[160:163], v[144:147], 0
    ds_read_b128 v[176:179], v224 offset:12288
    v_cvt_pk_bf16_f32 v48, v48, v49
    v_fma_f32 v54, v54, s26, v244
    v_exp_f32 v53, v53
    v_add_f32 v246, v246, v51
    v_fma_f32 v55, v55, s26, v244
    s_waitcnt lgkmcnt(3)
    v_mfma_f32_16x16x32_bf16 v[16:19], v[164:167], v[132:135], v[16:19]
    v_mfma_f32_16x16x32_bf16 v[24:27], v[164:167], v[148:151], v[24:27]
    ds_read_b128 v[180:183], v225 offset:12288
    s_mov_b32 m0, s23
    s_add_u32 s27, s20, 32768
    buffer_load_dwordx4 v236, s[8:11], s27 offen nt lds
    v_exp_f32 v54, v54
    v_add_f32 v246, v246, v52
    v_cvt_pk_bf16_f32 v49, v50, v51
    v_exp_f32 v55, v55
    v_add_f32 v246, v246, v53
    v_add_f32 v246, v246, v54
    s_waitcnt lgkmcnt(3)
    v_mfma_f32_16x16x32_bf16 v[16:19], v[168:171], v[136:139], v[16:19]
    v_mfma_f32_16x16x32_bf16 v[24:27], v[168:171], v[152:155], v[24:27]
    ds_read_b128 v[184:187], v226 offset:12288
    v_cvt_pk_bf16_f32 v50, v52, v53
    v_add_f32 v246, v246, v55
    v_cvt_pk_bf16_f32 v51, v54, v55
    v_fma_f32 v56, v56, s26, v245
    v_fma_f32 v57, v57, s26, v245
    s_waitcnt lgkmcnt(3)
    v_mfma_f32_16x16x32_bf16 v[16:19], v[172:175], v[140:143], v[16:19]
    v_mfma_f32_16x16x32_bf16 v[24:27], v[172:175], v[156:159], v[24:27]
    ds_read_b128 v[188:191], v227 offset:12288
    v_exp_f32 v56, v56
    v_fma_f32 v58, v58, s26, v245
    v_exp_f32 v57, v57
    v_fma_f32 v59, v59, s26, v245
    v_exp_f32 v58, v58
    s_waitcnt lgkmcnt(3)
    v_mfma_f32_16x16x32_bf16 v[20:23], v[176:179], v[128:131], 0
    v_mfma_f32_16x16x32_bf16 v[28:31], v[176:179], v[144:147], 0
    s_waitcnt vmcnt(9) lgkmcnt(0)
    s_barrier
    ds_read_b64_tr_b16 v[160:161], v228 offset:16384
    ds_read_b64_tr_b16 v[162:163], v228 offset:20480
    v_add_f32 v247, v247, v56
    v_fma_f32 v60, v60, s26, v245
    v_exp_f32 v59, v59
    v_add_f32 v247, v247, v57
    v_fma_f32 v61, v61, s26, v245
    v_mfma_f32_16x16x32_bf16 v[20:23], v[180:183], v[132:135], v[20:23]
    v_mfma_f32_16x16x32_bf16 v[28:31], v[180:183], v[148:151], v[28:31]
    ds_read_b64_tr_b16 v[164:165], v228 offset:24576
    ds_read_b64_tr_b16 v[166:167], v228 offset:28672
    buffer_load_dwordx4 v237, s[8:11], s27 offen offset:1024 nt lds
    v_exp_f32 v60, v60
    v_add_f32 v247, v247, v58
    v_cvt_pk_bf16_f32 v56, v56, v57
    v_fma_f32 v62, v62, s26, v245
    v_exp_f32 v61, v61
    v_add_f32 v247, v247, v59
    v_mfma_f32_16x16x32_bf16 v[20:23], v[184:187], v[136:139], v[20:23]
    v_mfma_f32_16x16x32_bf16 v[28:31], v[184:187], v[152:155], v[28:31]
    ds_read_b64_tr_b16 v[168:169], v229 offset:16384
    ds_read_b64_tr_b16 v[170:171], v229 offset:20480
    v_fma_f32 v63, v63, s26, v245
    v_exp_f32 v62, v62
    v_add_f32 v247, v247, v60
    v_cvt_pk_bf16_f32 v57, v58, v59
    v_exp_f32 v63, v63
    v_mfma_f32_16x16x32_bf16 v[20:23], v[188:191], v[140:143], v[20:23]
    v_mfma_f32_16x16x32_bf16 v[28:31], v[188:191], v[156:159], v[28:31]
    ds_read_b64_tr_b16 v[172:173], v229 offset:24576
    ds_read_b64_tr_b16 v[174:175], v229 offset:28672
    v_add_f32 v247, v247, v61
    v_add_f32 v247, v247, v62
    v_cvt_pk_bf16_f32 v58, v60, v61
    v_add_f32 v247, v247, v63
    v_cvt_pk_bf16_f32 v59, v62, v63
    s_waitcnt lgkmcnt(6)
    v_mfma_f32_16x16x32_bf16 v[64:67], v[160:163], v[32:35], v[64:67]
    v_mfma_f32_16x16x32_bf16 v[68:71], v[160:163], v[40:43], v[68:71]
    ds_read_b64_tr_b16 v[176:177], v230 offset:16384
    ds_read_b64_tr_b16 v[178:179], v230 offset:20480
    v_max_f32 v242, v0, v1
    v_max_f32 v243, v8, v9
    v_max3_f32 v242, v242, v2, v3
    v_max3_f32 v243, v243, v10, v11
    v_max3_f32 v242, v242, v4, v5
    v_max3_f32 v243, v243, v12, v13
    s_waitcnt lgkmcnt(6)
    v_mfma_f32_16x16x32_bf16 v[64:67], v[164:167], v[48:51], v[64:67]
    v_mfma_f32_16x16x32_bf16 v[68:71], v[164:167], v[56:59], v[68:71]
    ds_read_b64_tr_b16 v[180:181], v230 offset:24576
    ds_read_b64_tr_b16 v[182:183], v230 offset:28672
    s_add_u32 m0, s23, 16384
    s_add_u32 s27, s20, 16384
    buffer_load_dwordx4 v238, s[12:15], s27 offen nt lds
    v_mov_b32 v250, v246
    v_mov_b32 v251, v247
    v_max3_f32 v242, v242, v6, v7
    v_permlane16_swap_b32 v250, v246
    v_permlane16_swap_b32 v251, v247
    s_waitcnt lgkmcnt(6)
    v_mfma_f32_16x16x32_bf16 v[72:75], v[168:171], v[32:35], v[72:75]
    v_mfma_f32_16x16x32_bf16 v[76:79], v[168:171], v[40:43], v[76:79]
    ds_read_b64_tr_b16 v[184:185], v231 offset:16384
    ds_read_b64_tr_b16 v[186:187], v231 offset:20480
    v_add_f32 v246, v246, v250
    v_add_f32 v247, v247, v251
    v_mov_b32 v250, v246
    v_mov_b32 v251, v247
    v_max3_f32 v243, v243, v14, v15
    v_permlane32_swap_b32 v250, v246
    v_permlane32_swap_b32 v251, v247
    s_waitcnt lgkmcnt(6)
    v_mfma_f32_16x16x32_bf16 v[72:75], v[172:175], v[48:51], v[72:75]
    v_mfma_f32_16x16x32_bf16 v[76:79], v[172:175], v[56:59], v[76:79]
    ds_read_b64_tr_b16 v[188:189], v231 offset:24576
    ds_read_b64_tr_b16 v[190:191], v231 offset:28672
    v_add_f32 v246, v246, v250
    v_add_f32 v247, v247, v251
    v_rcp_f32 v248, v246
    v_rcp_f32 v249, v247
    v_max3_f32 v242, v242, v16, v17
    v_max3_f32 v243, v243, v24, v25
    v_max3_f32 v242, v242, v18, v19
    s_waitcnt lgkmcnt(6)
    v_mfma_f32_16x16x32_bf16 v[80:83], v[176:179], v[32:35], v[80:83]
    v_mfma_f32_16x16x32_bf16 v[84:87], v[176:179], v[40:43], v[84:87]
    ds_read_b64_tr_b16 v[160:161], v232 offset:16384
    ds_read_b64_tr_b16 v[162:163], v232 offset:20480
    v_max3_f32 v243, v243, v26, v27
    v_max3_f32 v242, v242, v20, v21
    v_max3_f32 v243, v243, v28, v29
    v_max3_f32 v242, v242, v22, v23
    v_max3_f32 v243, v243, v30, v31
    v_mov_b32 v250, v242
    s_waitcnt lgkmcnt(6)
    v_mfma_f32_16x16x32_bf16 v[80:83], v[180:183], v[48:51], v[80:83]
    v_mfma_f32_16x16x32_bf16 v[84:87], v[180:183], v[56:59], v[84:87]
    ds_read_b64_tr_b16 v[164:165], v232 offset:24576
    ds_read_b64_tr_b16 v[166:167], v232 offset:28672
    buffer_load_dwordx4 v239, s[12:15], s27 offen offset:1024 nt lds
    v_mov_b32 v251, v243
    v_mov_b32 v246, 0
    v_permlane16_swap_b32 v250, v242
    v_permlane16_swap_b32 v251, v243
    v_max_f32 v242, v242, v250
    v_max_f32 v243, v243, v251
    v_mov_b32 v250, v242
    s_waitcnt lgkmcnt(6)
    v_mfma_f32_16x16x32_bf16 v[88:91], v[184:187], v[32:35], v[88:91]
    v_mfma_f32_16x16x32_bf16 v[92:95], v[184:187], v[40:43], v[92:95]
    ds_read_b64_tr_b16 v[168:169], v233 offset:16384
    ds_read_b64_tr_b16 v[170:171], v233 offset:20480
    v_mov_b32 v251, v243
    v_mov_b32 v247, 0
    v_permlane32_swap_b32 v250, v242
    v_permlane32_swap_b32 v251, v243
    v_max_f32 v242, v242, v250
    v_max_f32 v243, v243, v251
    v_mul_f32 v244, s31, v242
    s_waitcnt lgkmcnt(6)
    v_mfma_f32_16x16x32_bf16 v[88:91], v[188:191], v[48:51], v[88:91]
    v_mfma_f32_16x16x32_bf16 v[92:95], v[188:191], v[56:59], v[92:95]
    ds_read_b64_tr_b16 v[172:173], v233 offset:24576
    ds_read_b64_tr_b16 v[174:175], v233 offset:28672
    v_mul_f32 v245, s31, v243
    v_fma_f32 v0, v0, s26, v244
    v_fma_f32 v1, v1, s26, v244
    v_exp_f32 v0, v0
    v_fma_f32 v2, v2, s26, v244
    v_exp_f32 v1, v1
    s_waitcnt lgkmcnt(6)
    v_mfma_f32_16x16x32_bf16 v[96:99], v[160:163], v[32:35], v[96:99]
    v_mfma_f32_16x16x32_bf16 v[100:103], v[160:163], v[40:43], v[100:103]
    ds_read_b64_tr_b16 v[176:177], v234 offset:16384
    ds_read_b64_tr_b16 v[178:179], v234 offset:20480
    v_fma_f32 v3, v3, s26, v244
    v_exp_f32 v2, v2
    v_add_f32 v246, v246, v0
    v_fma_f32 v4, v4, s26, v244
    v_exp_f32 v3, v3
    v_add_f32 v246, v246, v1
    v_fma_f32 v5, v5, s26, v244
    s_waitcnt lgkmcnt(6)
    v_mfma_f32_16x16x32_bf16 v[96:99], v[164:167], v[48:51], v[96:99]
    v_mfma_f32_16x16x32_bf16 v[100:103], v[164:167], v[56:59], v[100:103]
    ds_read_b64_tr_b16 v[180:181], v234 offset:24576
    ds_read_b64_tr_b16 v[182:183], v234 offset:28672
    s_mov_b32 m0, s22
    s_nop 0
    buffer_load_dwordx4 v236, s[4:7], s21 offen nt lds
    v_exp_f32 v4, v4
    v_add_f32 v246, v246, v2
    v_cvt_pk_bf16_f32 v0, v0, v1
    v_fma_f32 v6, v6, s26, v244
    v_exp_f32 v5, v5
    v_add_f32 v246, v246, v3
    v_fma_f32 v7, v7, s26, v244
    s_waitcnt lgkmcnt(6)
    v_mfma_f32_16x16x32_bf16 v[104:107], v[168:171], v[32:35], v[104:107]
    v_mfma_f32_16x16x32_bf16 v[108:111], v[168:171], v[40:43], v[108:111]
    ds_read_b64_tr_b16 v[184:185], v235 offset:16384
    ds_read_b64_tr_b16 v[186:187], v235 offset:20480
    v_exp_f32 v6, v6
    v_add_f32 v246, v246, v4
    v_cvt_pk_bf16_f32 v1, v2, v3
    v_exp_f32 v7, v7
    v_add_f32 v246, v246, v5
    v_add_f32 v246, v246, v6
    s_waitcnt lgkmcnt(6)
    v_mfma_f32_16x16x32_bf16 v[104:107], v[172:175], v[48:51], v[104:107]
    v_mfma_f32_16x16x32_bf16 v[108:111], v[172:175], v[56:59], v[108:111]
    ds_read_b64_tr_b16 v[188:189], v235 offset:24576
    ds_read_b64_tr_b16 v[190:191], v235 offset:28672
    v_cvt_pk_bf16_f32 v2, v4, v5
    v_add_f32 v246, v246, v7
    v_cvt_pk_bf16_f32 v3, v6, v7
    v_fma_f32 v8, v8, s26, v245
    v_fma_f32 v9, v9, s26, v245
    v_exp_f32 v8, v8
    v_fma_f32 v10, v10, s26, v245
    s_waitcnt lgkmcnt(6)
    v_mfma_f32_16x16x32_bf16 v[112:115], v[176:179], v[32:35], v[112:115]
    v_mfma_f32_16x16x32_bf16 v[116:119], v[176:179], v[40:43], v[116:119]
    s_waitcnt vmcnt(9) lgkmcnt(0)
    s_barrier
    ds_read_b128 v[160:163], v224 offset:32768
    v_exp_f32 v9, v9
    v_fma_f32 v11, v11, s26, v245
    v_exp_f32 v10, v10
    v_add_f32 v247, v247, v8
    v_fma_f32 v12, v12, s26, v245
    v_exp_f32 v11, v11
    v_add_f32 v247, v247, v9
    v_mfma_f32_16x16x32_bf16 v[112:115], v[180:183], v[48:51], v[112:115]
    v_mfma_f32_16x16x32_bf16 v[116:119], v[180:183], v[56:59], v[116:119]
    ds_read_b128 v[164:167], v225 offset:32768
    buffer_load_dwordx4 v237, s[4:7], s21 offen offset:1024 nt lds
    v_fma_f32 v13, v13, s26, v245
    v_mul_f32 v64, v64, v248
    v_mul_f32 v65, v65, v248
    v_mul_f32 v66, v66, v248
    v_mul_f32 v67, v67, v248
    v_cvt_pk_bf16_f32 v192, v64, v65
    v_exp_f32 v12, v12
    v_mfma_f32_16x16x32_bf16 v[120:123], v[184:187], v[32:35], v[120:123]
    v_mfma_f32_16x16x32_bf16 v[124:127], v[184:187], v[40:43], v[124:127]
    ds_read_b128 v[168:171], v226 offset:32768
    v_cvt_pk_bf16_f32 v193, v66, v67
    ds_write_b64 v252, v[192:193] offset:0
    v_mul_f32 v68, v68, v249
    v_mul_f32 v69, v69, v249
    v_mul_f32 v70, v70, v249
    v_add_f32 v247, v247, v10
    v_mul_f32 v71, v71, v249
    v_mfma_f32_16x16x32_bf16 v[120:123], v[188:191], v[48:51], v[120:123]
    v_mfma_f32_16x16x32_bf16 v[124:127], v[188:191], v[56:59], v[124:127]
    ds_read_b128 v[172:175], v227 offset:32768
    v_cvt_pk_bf16_f32 v208, v68, v69
    v_cvt_pk_bf16_f32 v209, v70, v71
    v_mul_f32 v72, v72, v248
    v_mul_f32 v73, v73, v248
    v_cvt_pk_bf16_f32 v8, v8, v9
    v_mul_f32 v74, v74, v248
    v_mul_f32 v75, v75, v248
    s_waitcnt lgkmcnt(4)
    v_mfma_f32_16x16x32_bf16 v[32:35], v[160:163], v[128:131], 0
    v_mfma_f32_16x16x32_bf16 v[40:43], v[160:163], v[144:147], 0
    ds_read_b128 v[176:179], v224 offset:36864
    v_cvt_pk_bf16_f32 v194, v72, v73
    v_cvt_pk_bf16_f32 v195, v74, v75
    v_xor_b32 v250, 32, v252
    v_fma_f32 v14, v14, s26, v245
    ds_write_b64 v250, v[194:195] offset:0
    v_mul_f32 v76, v76, v249
    v_mul_f32 v77, v77, v249
    v_mul_f32 v78, v78, v249
    s_waitcnt lgkmcnt(5)
    v_mfma_f32_16x16x32_bf16 v[32:35], v[164:167], v[132:135], v[32:35]
    v_mfma_f32_16x16x32_bf16 v[40:43], v[164:167], v[148:151], v[40:43]
    ds_read_b128 v[180:183], v225 offset:36864
    s_add_u32 m0, s23, 32768
    s_add_u32 s27, s20, 49152
    buffer_load_dwordx4 v236, s[8:11], s27 offen nt lds
    v_mul_f32 v79, v79, v249
    v_exp_f32 v13, v13
    v_cvt_pk_bf16_f32 v210, v76, v77
    v_cvt_pk_bf16_f32 v211, v78, v79
    v_mul_f32 v80, v80, v248
    v_mul_f32 v81, v81, v248
    s_waitcnt lgkmcnt(5)
    v_mfma_f32_16x16x32_bf16 v[32:35], v[168:171], v[136:139], v[32:35]
    v_mfma_f32_16x16x32_bf16 v[40:43], v[168:171], v[152:155], v[40:43]
    ds_read_b128 v[184:187], v226 offset:36864
    v_mul_f32 v82, v82, v248
    v_add_f32 v247, v247, v11
    v_mul_f32 v83, v83, v248
    v_cvt_pk_bf16_f32 v196, v80, v81
    v_cvt_pk_bf16_f32 v197, v82, v83
    v_xor_b32 v250, 64, v252
    ds_write_b64 v250, v[196:197] offset:0
    v_fma_f32 v15, v15, s26, v245
    s_waitcnt lgkmcnt(5)
    v_mfma_f32_16x16x32_bf16 v[32:35], v[172:175], v[140:143], v[32:35]
    v_mfma_f32_16x16x32_bf16 v[40:43], v[172:175], v[156:159], v[40:43]
    ds_read_b128 v[188:191], v227 offset:36864
    v_mul_f32 v84, v84, v249
    v_mul_f32 v85, v85, v249
    v_mul_f32 v86, v86, v249
    v_mul_f32 v87, v87, v249
    v_cvt_pk_bf16_f32 v212, v84, v85
    v_exp_f32 v14, v14
    v_cvt_pk_bf16_f32 v213, v86, v87
    s_waitcnt lgkmcnt(5)
    v_mfma_f32_16x16x32_bf16 v[36:39], v[176:179], v[128:131], 0
    v_mfma_f32_16x16x32_bf16 v[44:47], v[176:179], v[144:147], 0
    ds_read_b128 v[160:163], v224 offset:40960
    v_mul_f32 v88, v88, v248
    v_mul_f32 v89, v89, v248
    v_mul_f32 v90, v90, v248
    v_mul_f32 v91, v91, v248
    v_add_f32 v247, v247, v12
    v_cvt_pk_bf16_f32 v198, v88, v89
    s_waitcnt lgkmcnt(4)
    v_mfma_f32_16x16x32_bf16 v[36:39], v[180:183], v[132:135], v[36:39]
    v_mfma_f32_16x16x32_bf16 v[44:47], v[180:183], v[148:151], v[44:47]
    ds_read_b128 v[164:167], v225 offset:40960
    buffer_load_dwordx4 v237, s[8:11], s27 offen offset:1024 nt lds
    v_cvt_pk_bf16_f32 v199, v90, v91
    v_xor_b32 v250, 96, v252
    ds_write_b64 v250, v[198:199] offset:0
    v_mul_f32 v92, v92, v249
    v_cvt_pk_bf16_f32 v9, v10, v11
    v_mul_f32 v93, v93, v249
    v_mul_f32 v94, v94, v249
    v_mul_f32 v95, v95, v249
    s_waitcnt lgkmcnt(5)
    v_mfma_f32_16x16x32_bf16 v[36:39], v[184:187], v[136:139], v[36:39]
    v_mfma_f32_16x16x32_bf16 v[44:47], v[184:187], v[152:155], v[44:47]
    ds_read_b128 v[168:171], v226 offset:40960
    v_cvt_pk_bf16_f32 v214, v92, v93
    v_cvt_pk_bf16_f32 v215, v94, v95
    v_exp_f32 v15, v15
    v_mul_f32 v96, v96, v248
    v_mul_f32 v97, v97, v248
    v_mul_f32 v98, v98, v248
    v_mul_f32 v99, v99, v248
    s_waitcnt lgkmcnt(4)
    v_mfma_f32_16x16x32_bf16 v[36:39], v[188:191], v[140:143], v[36:39]
    v_mfma_f32_16x16x32_bf16 v[44:47], v[188:191], v[156:159], v[44:47]
    ds_read_b128 v[172:175], v227 offset:40960
    v_cvt_pk_bf16_f32 v200, v96, v97
    v_add_f32 v247, v247, v13
    v_cvt_pk_bf16_f32 v201, v98, v99
    ds_write_b64 v252, v[200:201] offset:128
    v_mul_f32 v100, v100, v249
    v_mul_f32 v101, v101, v249
    v_mul_f32 v102, v102, v249
    v_add_f32 v247, v247, v14
    s_waitcnt lgkmcnt(5)
    v_mfma_f32_16x16x32_bf16 v[48:51], v[160:163], v[128:131], 0
    v_mfma_f32_16x16x32_bf16 v[56:59], v[160:163], v[144:147], 0
    ds_read_b128 v[176:179], v224 offset:45056
    v_mul_f32 v103, v103, v249
    v_cvt_pk_bf16_f32 v216, v100, v101
    v_cvt_pk_bf16_f32 v217, v102, v103
    v_mul_f32 v104, v104, v248
    v_mul_f32 v105, v105, v248
    v_cvt_pk_bf16_f32 v10, v12, v13
    s_waitcnt lgkmcnt(5)
    v_mfma_f32_16x16x32_bf16 v[48:51], v[164:167], v[132:135], v[48:51]
    v_mfma_f32_16x16x32_bf16 v[56:59], v[164:167], v[148:151], v[56:59]
    ds_read_b128 v[180:183], v225 offset:45056
    s_add_u32 m0, s22, 16384
    s_add_u32 s27, s21, 16384
    buffer_load_dwordx4 v236, s[4:7], s27 offen nt lds
    v_mul_f32 v106, v106, v248
    v_mul_f32 v107, v107, v248
    v_cvt_pk_bf16_f32 v202, v104, v105
    v_cvt_pk_bf16_f32 v203, v106, v107
    v_xor_b32 v250, 32, v252
    v_add_f32 v247, v247, v15
    ds_write_b64 v250, v[202:203] offset:128
    v_mul_f32 v108, v108, v249
    s_waitcnt lgkmcnt(5)
    v_mfma_f32_16x16x32_bf16 v[48:51], v[168:171], v[136:139], v[48:51]
    v_mfma_f32_16x16x32_bf16 v[56:59], v[168:171], v[152:155], v[56:59]
    ds_read_b128 v[184:187], v226 offset:45056
    v_mul_f32 v109, v109, v249
    v_mul_f32 v110, v110, v249
    v_mul_f32 v111, v111, v249
    v_cvt_pk_bf16_f32 v11, v14, v15
    v_cvt_pk_bf16_f32 v218, v108, v109
    v_cvt_pk_bf16_f32 v219, v110, v111
    v_mul_f32 v112, v112, v248
    s_waitcnt lgkmcnt(5)
    v_mfma_f32_16x16x32_bf16 v[48:51], v[172:175], v[140:143], v[48:51]
    v_mfma_f32_16x16x32_bf16 v[56:59], v[172:175], v[156:159], v[56:59]
    ds_read_b128 v[188:191], v227 offset:45056
    v_mul_f32 v113, v113, v248
    v_mul_f32 v114, v114, v248
    v_mul_f32 v115, v115, v248
    v_cvt_pk_bf16_f32 v204, v112, v113
    v_cvt_pk_bf16_f32 v205, v114, v115
    v_xor_b32 v250, 64, v252
    ds_write_b64 v250, v[204:205] offset:128
    s_waitcnt lgkmcnt(5)
    v_mfma_f32_16x16x32_bf16 v[52:55], v[176:179], v[128:131], 0
    v_mfma_f32_16x16x32_bf16 v[60:63], v[176:179], v[144:147], 0
    s_waitcnt vmcnt(9) lgkmcnt(0)
    s_barrier
    ds_read_b64_tr_b16 v[160:161], v228 offset:49152
    ds_read_b64_tr_b16 v[162:163], v228 offset:53248
    v_mul_f32 v116, v116, v249
    v_mul_f32 v117, v117, v249
    v_mul_f32 v118, v118, v249
    v_mul_f32 v119, v119, v249
    v_cvt_pk_bf16_f32 v220, v116, v117
    v_cvt_pk_bf16_f32 v221, v118, v119
    v_mul_f32 v120, v120, v248
    v_mfma_f32_16x16x32_bf16 v[52:55], v[180:183], v[132:135], v[52:55]
    v_mfma_f32_16x16x32_bf16 v[60:63], v[180:183], v[148:151], v[60:63]
    ds_read_b64_tr_b16 v[164:165], v229 offset:49152
    ds_read_b64_tr_b16 v[166:167], v229 offset:53248
    buffer_load_dwordx4 v237, s[4:7], s27 offen offset:1024 nt lds
    v_mul_f32 v121, v121, v248
    v_mul_f32 v122, v122, v248
    v_mul_f32 v123, v123, v248
    v_cvt_pk_bf16_f32 v206, v120, v121
    v_cvt_pk_bf16_f32 v207, v122, v123
    v_xor_b32 v250, 96, v252
    ds_write_b64 v250, v[206:207] offset:128
    v_mul_f32 v124, v124, v249
    v_mfma_f32_16x16x32_bf16 v[52:55], v[184:187], v[136:139], v[52:55]
    v_mfma_f32_16x16x32_bf16 v[60:63], v[184:187], v[152:155], v[60:63]
    ds_read_b64_tr_b16 v[168:169], v230 offset:49152
    ds_read_b64_tr_b16 v[170:171], v230 offset:53248
    v_mul_f32 v125, v125, v249
    v_mul_f32 v126, v126, v249
    v_mul_f32 v127, v127, v249
    v_cvt_pk_bf16_f32 v222, v124, v125
    v_cvt_pk_bf16_f32 v223, v126, v127
    ds_read_b128 v[192:195], v240 offset:0
    ds_read_b128 v[196:199], v240 offset:1024
    ds_read_b128 v[200:203], v240 offset:2048
    ds_read_b128 v[204:207], v240 offset:3072
    ds_write_b64 v252, v[208:209] offset:0
    v_xor_b32 v250, 32, v252
    ds_write_b64 v250, v[210:211] offset:0
    v_mfma_f32_16x16x32_bf16 v[52:55], v[188:191], v[140:143], v[52:55]
    v_mfma_f32_16x16x32_bf16 v[60:63], v[188:191], v[156:159], v[60:63]
    ds_read_b64_tr_b16 v[172:173], v231 offset:49152
    ds_read_b64_tr_b16 v[174:175], v231 offset:53248
    v_xor_b32 v250, 64, v252
    s_waitcnt lgkmcnt(14)
    ds_write_b64 v250, v[212:213] offset:0
    v_xor_b32 v250, 96, v252
    s_waitcnt lgkmcnt(14)
    ds_write_b64 v250, v[214:215] offset:0
    s_waitcnt lgkmcnt(14)
    ds_write_b64 v252, v[216:217] offset:128
    v_xor_b32 v250, 32, v252
    s_waitcnt lgkmcnt(14)
    ds_write_b64 v250, v[218:219] offset:128
    v_xor_b32 v250, 64, v252
    s_waitcnt lgkmcnt(14)
    ds_write_b64 v250, v[220:221] offset:128
    v_xor_b32 v250, 96, v252
    s_waitcnt lgkmcnt(14)
    ds_write_b64 v250, v[222:223] offset:128
    s_waitcnt lgkmcnt(14)
    ds_read_b128 v[208:211], v240 offset:0
    s_waitcnt lgkmcnt(14)
    ds_read_b128 v[212:215], v240 offset:1024
    s_waitcnt lgkmcnt(14)
    ds_read_b128 v[216:219], v240 offset:2048
    s_waitcnt lgkmcnt(14)
    ds_read_b128 v[220:223], v240 offset:3072
    v_fma_f32 v16, v16, s26, v244
    v_fma_f32 v17, v17, s26, v244
    v_mfma_f32_16x16x32_bf16 v[64:67], v[160:163], v[0:3], 0
    v_mfma_f32_16x16x32_bf16 v[68:71], v[160:163], v[8:11], 0
    s_waitcnt lgkmcnt(14)
    ds_read_b64_tr_b16 v[176:177], v232 offset:49152
    s_waitcnt lgkmcnt(14)
    ds_read_b64_tr_b16 v[178:179], v232 offset:53248
    v_exp_f32 v16, v16
    v_fma_f32 v18, v18, s26, v244
    v_exp_f32 v17, v17
    v_fma_f32 v19, v19, s26, v244
    v_exp_f32 v18, v18
    v_add_f32 v246, v246, v16
    v_fma_f32 v20, v20, s26, v244
    v_mfma_f32_16x16x32_bf16 v[72:75], v[164:167], v[0:3], 0
    v_mfma_f32_16x16x32_bf16 v[76:79], v[164:167], v[8:11], 0
    s_waitcnt lgkmcnt(14)
    ds_read_b64_tr_b16 v[180:181], v233 offset:49152
    s_waitcnt lgkmcnt(14)
    ds_read_b64_tr_b16 v[182:183], v233 offset:53248
    s_add_u32 m0, s23, 49152
    s_add_u32 s27, s20, 32768
    buffer_load_dwordx4 v238, s[12:15], s27 offen nt lds
    v_exp_f32 v19, v19
    v_add_f32 v246, v246, v17
    v_fma_f32 v21, v21, s26, v244
    v_exp_f32 v20, v20
    v_add_f32 v246, v246, v18
    v_cvt_pk_bf16_f32 v16, v16, v17
    v_fma_f32 v22, v22, s26, v244
    v_mfma_f32_16x16x32_bf16 v[80:83], v[168:171], v[0:3], 0
    v_mfma_f32_16x16x32_bf16 v[84:87], v[168:171], v[8:11], 0
    s_waitcnt lgkmcnt(14)
    ds_read_b64_tr_b16 v[184:185], v234 offset:49152
    s_waitcnt lgkmcnt(14)
    ds_read_b64_tr_b16 v[186:187], v234 offset:53248
    v_exp_f32 v21, v21
    v_add_f32 v246, v246, v19
    v_fma_f32 v23, v23, s26, v244
    v_exp_f32 v22, v22
    v_add_f32 v246, v246, v20
    v_cvt_pk_bf16_f32 v17, v18, v19
    v_mfma_f32_16x16x32_bf16 v[88:91], v[172:175], v[0:3], 0
    v_mfma_f32_16x16x32_bf16 v[92:95], v[172:175], v[8:11], 0
    s_waitcnt lgkmcnt(14)
    ds_read_b64_tr_b16 v[188:189], v235 offset:49152
    s_waitcnt lgkmcnt(14)
    ds_read_b64_tr_b16 v[190:191], v235 offset:53248
    v_exp_f32 v23, v23
    v_add_f32 v246, v246, v21
    v_add_f32 v246, v246, v22
    v_cvt_pk_bf16_f32 v18, v20, v21
    v_add_f32 v246, v246, v23
    v_cvt_pk_bf16_f32 v19, v22, v23
    v_fma_f32 v24, v24, s26, v245
    s_waitcnt lgkmcnt(6)
    v_mfma_f32_16x16x32_bf16 v[96:99], v[176:179], v[0:3], 0
    v_mfma_f32_16x16x32_bf16 v[100:103], v[176:179], v[8:11], 0
    ds_read_b64_tr_b16 v[160:161], v228 offset:57344
    ds_read_b64_tr_b16 v[162:163], v228 offset:61440
    v_fma_f32 v25, v25, s26, v245
    v_exp_f32 v24, v24
    v_fma_f32 v26, v26, s26, v245
    v_exp_f32 v25, v25
    v_fma_f32 v27, v27, s26, v245
    v_exp_f32 v26, v26
    v_add_f32 v247, v247, v24
    v_xor_b32 v224, 0x10000, v224
    s_waitcnt lgkmcnt(6)
    v_mfma_f32_16x16x32_bf16 v[104:107], v[180:183], v[0:3], 0
    v_mfma_f32_16x16x32_bf16 v[108:111], v[180:183], v[8:11], 0
    ds_read_b64_tr_b16 v[164:165], v229 offset:57344
    ds_read_b64_tr_b16 v[166:167], v229 offset:61440
    buffer_load_dwordx4 v239, s[12:15], s27 offen offset:1024 nt lds
    v_fma_f32 v28, v28, s26, v245
    v_exp_f32 v27, v27
    v_add_f32 v247, v247, v25
    v_fma_f32 v29, v29, s26, v245
    v_exp_f32 v28, v28
    v_add_f32 v247, v247, v26
    v_xor_b32 v225, 0x10000, v225
    s_waitcnt lgkmcnt(6)
    v_mfma_f32_16x16x32_bf16 v[112:115], v[184:187], v[0:3], 0
    v_mfma_f32_16x16x32_bf16 v[116:119], v[184:187], v[8:11], 0
    ds_read_b64_tr_b16 v[168:169], v230 offset:57344
    ds_read_b64_tr_b16 v[170:171], v230 offset:61440
    v_cvt_pk_bf16_f32 v24, v24, v25
    v_fma_f32 v30, v30, s26, v245
    v_exp_f32 v29, v29
    v_add_f32 v247, v247, v27
    v_fma_f32 v31, v31, s26, v245
    v_exp_f32 v30, v30
    v_add_f32 v247, v247, v28
    v_xor_b32 v226, 0x10000, v226
    s_waitcnt lgkmcnt(6)
    v_mfma_f32_16x16x32_bf16 v[120:123], v[188:191], v[0:3], 0
    v_mfma_f32_16x16x32_bf16 v[124:127], v[188:191], v[8:11], 0
    ds_read_b64_tr_b16 v[172:173], v231 offset:57344
    ds_read_b64_tr_b16 v[174:175], v231 offset:61440
    v_cvt_pk_bf16_f32 v25, v26, v27
    v_exp_f32 v31, v31
    v_add_f32 v247, v247, v29
    v_add_f32 v247, v247, v30
    v_cvt_pk_bf16_f32 v26, v28, v29
    v_add_f32 v247, v247, v31
    v_cvt_pk_bf16_f32 v27, v30, v31
    v_xor_b32 v227, 0x10000, v227
    s_waitcnt lgkmcnt(6)
    v_mfma_f32_16x16x32_bf16 v[64:67], v[160:163], v[16:19], v[64:67]
    v_mfma_f32_16x16x32_bf16 v[68:71], v[160:163], v[24:27], v[68:71]
    ds_read_b64_tr_b16 v[176:177], v232 offset:57344
    ds_read_b64_tr_b16 v[178:179], v232 offset:61440
    v_max_f32 v242, v32, v33
    v_max_f32 v243, v40, v41
    v_max3_f32 v242, v242, v34, v35
    v_max3_f32 v243, v243, v42, v43
    v_max3_f32 v242, v242, v36, v37
    v_max3_f32 v243, v243, v44, v45
    s_waitcnt lgkmcnt(6)
    v_mfma_f32_16x16x32_bf16 v[72:75], v[164:167], v[16:19], v[72:75]
    v_mfma_f32_16x16x32_bf16 v[76:79], v[164:167], v[24:27], v[76:79]
    ds_read_b64_tr_b16 v[180:181], v233 offset:57344
    ds_read_b64_tr_b16 v[182:183], v233 offset:61440
    s_add_u32 m0, s22, 32768
    s_add_u32 s27, s21, 32768
    buffer_load_dwordx4 v236, s[4:7], s27 offen nt lds
    v_max3_f32 v242, v242, v38, v39
    v_max3_f32 v243, v243, v46, v47
    v_max3_f32 v242, v242, v48, v49
    v_max3_f32 v243, v243, v56, v57
    v_max3_f32 v242, v242, v50, v51
    s_waitcnt lgkmcnt(6)
    v_mfma_f32_16x16x32_bf16 v[80:83], v[168:171], v[16:19], v[80:83]
    v_mfma_f32_16x16x32_bf16 v[84:87], v[168:171], v[24:27], v[84:87]
    ds_read_b64_tr_b16 v[184:185], v234 offset:57344
    ds_read_b64_tr_b16 v[186:187], v234 offset:61440
    v_max3_f32 v243, v243, v58, v59
    v_max3_f32 v242, v242, v52, v53
    v_max3_f32 v243, v243, v60, v61
    v_max3_f32 v242, v242, v54, v55
    s_waitcnt lgkmcnt(6)
    v_mfma_f32_16x16x32_bf16 v[88:91], v[172:175], v[16:19], v[88:91]
    v_mfma_f32_16x16x32_bf16 v[92:95], v[172:175], v[24:27], v[92:95]
    ds_read_b64_tr_b16 v[188:189], v235 offset:57344
    ds_read_b64_tr_b16 v[190:191], v235 offset:61440
    v_max3_f32 v243, v243, v62, v63
    v_fma_f32 v250, v242, s26, v244
    v_fma_f32 v251, v243, s26, v245
    v_max_f32 v250, v250, v251
    v_cmp_lt_f32 vcc, s35, v250
    s_cbranch_vccnz L_rare1
L_back1:
    s_waitcnt lgkmcnt(6)
    v_mfma_f32_16x16x32_bf16 v[96:99], v[176:179], v[16:19], v[96:99]
    v_mfma_f32_16x16x32_bf16 v[100:103], v[176:179], v[24:27], v[100:103]
    s_waitcnt vmcnt(11) lgkmcnt(0)
    s_barrier
    ds_read_b128 v[160:163], v224 offset:0
    v_fma_f32 v32, v32, s26, v244
    v_fma_f32 v33, v33, s26, v244
    v_exp_f32 v32, v32
    v_fma_f32 v34, v34, s26, v244
    v_mfma_f32_16x16x32_bf16 v[104:107], v[180:183], v[16:19], v[104:107]
    v_mfma_f32_16x16x32_bf16 v[108:111], v[180:183], v[24:27], v[108:111]
    ds_read_b128 v[164:167], v225 offset:0
    buffer_load_dwordx4 v237, s[4:7], s27 offen offset:1024 nt lds
    v_exp_f32 v33, v33
    v_fma_f32 v35, v35, s26, v244
    v_exp_f32 v34, v34
    v_add_f32 v246, v246, v32
    v_mfma_f32_16x16x32_bf16 v[112:115], v[184:187], v[16:19], v[112:115]
    v_mfma_f32_16x16x32_bf16 v[116:119], v[184:187], v[24:27], v[116:119]
    ds_read_b128 v[168:171], v226 offset:0
    v_fma_f32 v36, v36, s26, v244
    v_exp_f32 v35, v35
    v_add_f32 v246, v246, v33
    v_fma_f32 v37, v37, s26, v244
    v_exp_f32 v36, v36
    v_mfma_f32_16x16x32_bf16 v[120:123], v[188:191], v[16:19], v[120:123]
    v_mfma_f32_16x16x32_bf16 v[124:127], v[188:191], v[24:27], v[124:127]
    ds_read_b128 v[172:175], v227 offset:0
    v_add_f32 v246, v246, v34
    v_cvt_pk_bf16_f32 v32, v32, v33
    v_fma_f32 v38, v38, s26, v244
    v_exp_f32 v37, v37
    s_waitcnt lgkmcnt(3)
    v_mfma_f32_16x16x32_bf16 v[0:3], v[160:163], v[128:131], 0
    v_mfma_f32_16x16x32_bf16 v[8:11], v[160:163], v[144:147], 0
    ds_read_b128 v[176:179], v224 offset:4096
    v_add_f32 v246, v246, v35
    v_fma_f32 v39, v39, s26, v244
    v_exp_f32 v38, v38
    v_add_f32 v246, v246, v36
    v_cvt_pk_bf16_f32 v33, v34, v35
    s_waitcnt lgkmcnt(3)
    v_mfma_f32_16x16x32_bf16 v[0:3], v[164:167], v[132:135], v[0:3]
    v_mfma_f32_16x16x32_bf16 v[8:11], v[164:167], v[148:151], v[8:11]
    ds_read_b128 v[180:183], v225 offset:4096
    s_add_u32 m0, s22, 49152
    s_add_u32 s27, s21, 49152
    buffer_load_dwordx4 v236, s[4:7], s27 offen nt lds
    v_exp_f32 v39, v39
    v_add_f32 v246, v246, v37
    v_add_f32 v246, v246, v38
    v_cvt_pk_bf16_f32 v34, v36, v37
    s_waitcnt lgkmcnt(3)
    v_mfma_f32_16x16x32_bf16 v[0:3], v[168:171], v[136:139], v[0:3]
    v_mfma_f32_16x16x32_bf16 v[8:11], v[168:171], v[152:155], v[8:11]
    ds_read_b128 v[184:187], v226 offset:4096
    v_add_f32 v246, v246, v39
    v_cvt_pk_bf16_f32 v35, v38, v39
    v_fma_f32 v40, v40, s26, v245
    v_fma_f32 v41, v41, s26, v245
    v_xor_b32 v228, 0x10000, v228
    s_waitcnt lgkmcnt(3)
    v_mfma_f32_16x16x32_bf16 v[0:3], v[172:175], v[140:143], v[0:3]
    v_mfma_f32_16x16x32_bf16 v[8:11], v[172:175], v[156:159], v[8:11]
    ds_read_b128 v[188:191], v227 offset:4096
    v_exp_f32 v40, v40
    v_fma_f32 v42, v42, s26, v245
    v_exp_f32 v41, v41
    v_fma_f32 v43, v43, s26, v245
    v_exp_f32 v42, v42
    v_xor_b32 v229, 0x10000, v229
    s_waitcnt lgkmcnt(3)
    v_mfma_f32_16x16x32_bf16 v[4:7], v[176:179], v[128:131], 0
    v_mfma_f32_16x16x32_bf16 v[12:15], v[176:179], v[144:147], 0
    ds_read_b128 v[160:163], v224 offset:8192
    v_add_f32 v247, v247, v40
    v_fma_f32 v44, v44, s26, v245
    v_exp_f32 v43, v43
    v_add_f32 v247, v247, v41
    v_xor_b32 v230, 0x10000, v230
    s_waitcnt lgkmcnt(3)
    v_mfma_f32_16x16x32_bf16 v[4:7], v[180:183], v[132:135], v[4:7]
    v_mfma_f32_16x16x32_bf16 v[12:15], v[180:183], v[148:151], v[12:15]
    ds_read_b128 v[164:167], v225 offset:8192
    buffer_load_dwordx4 v237, s[4:7], s27 offen offset:1024 nt lds
    v_fma_f32 v45, v45, s26, v245
    v_exp_f32 v44, v44
    v_add_f32 v247, v247, v42
    v_cvt_pk_bf16_f32 v40, v40, v41
    v_fma_f32 v46, v46, s26, v245
    v_xor_b32 v231, 0x10000, v231
    s_waitcnt lgkmcnt(3)
    v_mfma_f32_16x16x32_bf16 v[4:7], v[184:187], v[136:139], v[4:7]
    v_mfma_f32_16x16x32_bf16 v[12:15], v[184:187], v[152:155], v[12:15]
    ds_read_b128 v[168:171], v226 offset:8192
    v_exp_f32 v45, v45
    v_add_f32 v247, v247, v43
    v_fma_f32 v47, v47, s26, v245
    v_exp_f32 v46, v46
    v_xor_b32 v232, 0x10000, v232
    s_waitcnt lgkmcnt(3)
    v_mfma_f32_16x16x32_bf16 v[4:7], v[188:191], v[140:143], v[4:7]
    v_mfma_f32_16x16x32_bf16 v[12:15], v[188:191], v[156:159], v[12:15]
    ds_read_b128 v[172:175], v227 offset:8192
    v_add_f32 v247, v247, v44
    v_cvt_pk_bf16_f32 v41, v42, v43
    v_exp_f32 v47, v47
    v_add_f32 v247, v247, v45
    v_xor_b32 v233, 0x10000, v233
    s_waitcnt lgkmcnt(3)
    v_mfma_f32_16x16x32_bf16 v[16:19], v[160:163], v[128:131], 0
    v_mfma_f32_16x16x32_bf16 v[24:27], v[160:163], v[144:147], 0
    ds_read_b128 v[176:179], v224 offset:12288
    v_add_f32 v247, v247, v46
    v_cvt_pk_bf16_f32 v42, v44, v45
    v_add_f32 v247, v247, v47
    v_cvt_pk_bf16_f32 v43, v46, v47
    v_fma_f32 v48, v48, s26, v244
    v_xor_b32 v234, 0x10000, v234
    s_waitcnt lgkmcnt(3)
    v_mfma_f32_16x16x32_bf16 v[16:19], v[164:167], v[132:135], v[16:19]
    v_mfma_f32_16x16x32_bf16 v[24:27], v[164:167], v[148:151], v[24:27]
    ds_read_b128 v[180:183], v225 offset:12288
    buffer_store_dwordx4 v[192:195], v241, s[16:19], s33 offen sc1
    v_fma_f32 v49, v49, s26, v244
    v_exp_f32 v48, v48
    v_fma_f32 v50, v50, s26, v244
    v_exp_f32 v49, v49
    v_xor_b32 v235, 0x10000, v235
    s_waitcnt lgkmcnt(3)
    v_mfma_f32_16x16x32_bf16 v[16:19], v[168:171], v[136:139], v[16:19]
    v_mfma_f32_16x16x32_bf16 v[24:27], v[168:171], v[152:155], v[24:27]
    ds_read_b128 v[184:187], v226 offset:12288
    v_fma_f32 v51, v51, s26, v244
    v_exp_f32 v50, v50
    v_add_f32 v246, v246, v48
    v_fma_f32 v52, v52, s26, v244
    v_exp_f32 v51, v51
    s_waitcnt lgkmcnt(3)
    v_mfma_f32_16x16x32_bf16 v[16:19], v[172:175], v[140:143], v[16:19]
    v_mfma_f32_16x16x32_bf16 v[24:27], v[172:175], v[156:159], v[24:27]
    ds_read_b128 v[188:191], v227 offset:12288
    v_add_f32 v246, v246, v49
    v_fma_f32 v53, v53, s26, v244
    v_exp_f32 v52, v52
    v_add_f32 v246, v246, v50
    s_waitcnt lgkmcnt(3)
    v_mfma_f32_16x16x32_bf16 v[20:23], v[176:179], v[128:131], 0
    v_mfma_f32_16x16x32_bf16 v[28:31], v[176:179], v[144:147], 0
    s_waitcnt vmcnt(13) lgkmcnt(0)
    s_barrier
    ds_read_b64_tr_b16 v[160:161], v228 offset:16384
    ds_read_b64_tr_b16 v[162:163], v228 offset:20480
    v_cvt_pk_bf16_f32 v48, v48, v49
    v_fma_f32 v54, v54, s26, v244
    v_exp_f32 v53, v53
    v_add_f32 v246, v246, v51
    v_mfma_f32_16x16x32_bf16 v[20:23], v[180:183], v[132:135], v[20:23]
    v_mfma_f32_16x16x32_bf16 v[28:31], v[180:183], v[148:151], v[28:31]
    ds_read_b64_tr_b16 v[164:165], v229 offset:16384
    ds_read_b64_tr_b16 v[166:167], v229 offset:20480
    buffer_store_dwordx4 v[196:199], v253, s[16:19], s33 offen offset:1024 sc1
    v_fma_f32 v55, v55, s26, v244
    v_exp_f32 v54, v54
    v_add_f32 v246, v246, v52
    v_cvt_pk_bf16_f32 v49, v50, v51
    v_exp_f32 v55, v55
    v_mfma_f32_16x16x32_bf16 v[20:23], v[184:187], v[136:139], v[20:23]
    v_mfma_f32_16x16x32_bf16 v[28:31], v[184:187], v[152:155], v[28:31]
    ds_read_b64_tr_b16 v[168:169], v230 offset:16384
    ds_read_b64_tr_b16 v[170:171], v230 offset:20480
    v_add_f32 v246, v246, v53
    v_add_f32 v246, v246, v54
    v_cvt_pk_bf16_f32 v50, v52, v53
    v_add_f32 v246, v246, v55
    v_mfma_f32_16x16x32_bf16 v[20:23], v[188:191], v[140:143], v[20:23]
    v_mfma_f32_16x16x32_bf16 v[28:31], v[188:191], v[156:159], v[28:31]
    ds_read_b64_tr_b16 v[172:173], v231 offset:16384
    ds_read_b64_tr_b16 v[174:175], v231 offset:20480
    v_cvt_pk_bf16_f32 v51, v54, v55
    v_max_f32 v242, v0, v1
    v_max_f32 v243, v8, v9
    v_max3_f32 v242, v242, v2, v3
    v_max3_f32 v243, v243, v10, v11
    s_waitcnt lgkmcnt(6)
    v_mfma_f32_16x16x32_bf16 v[64:67], v[160:163], v[32:35], v[64:67]
    v_mfma_f32_16x16x32_bf16 v[68:71], v[160:163], v[40:43], v[68:71]
    ds_read_b64_tr_b16 v[176:177], v232 offset:16384
    ds_read_b64_tr_b16 v[178:179], v232 offset:20480
    v_max3_f32 v242, v242, v4, v5
    v_max3_f32 v243, v243, v12, v13
    v_max3_f32 v242, v242, v6, v7
    v_max3_f32 v243, v243, v14, v15
    s_waitcnt lgkmcnt(6)
    v_mfma_f32_16x16x32_bf16 v[72:75], v[164:167], v[32:35], v[72:75]
    v_mfma_f32_16x16x32_bf16 v[76:79], v[164:167], v[40:43], v[76:79]
    ds_read_b64_tr_b16 v[180:181], v233 offset:16384
    ds_read_b64_tr_b16 v[182:183], v233 offset:20480
    s_mov_b32 m0, s23
    s_nop 0
    buffer_load_dwordx4 v236, s[8:11], s21 offen nt lds
    v_fma_f32 v56, v56, s26, v245
    v_fma_f32 v57, v57, s26, v245
    v_exp_f32 v56, v56
    v_fma_f32 v58, v58, s26, v245
    s_waitcnt lgkmcnt(6)
    v_mfma_f32_16x16x32_bf16 v[80:83], v[168:171], v[32:35], v[80:83]
    v_mfma_f32_16x16x32_bf16 v[84:87], v[168:171], v[40:43], v[84:87]
    ds_read_b64_tr_b16 v[184:185], v234 offset:16384
    ds_read_b64_tr_b16 v[186:187], v234 offset:20480
    v_exp_f32 v57, v57
    v_fma_f32 v59, v59, s26, v245
    v_exp_f32 v58, v58
    v_add_f32 v247, v247, v56
    v_fma_f32 v60, v60, s26, v245
    s_waitcnt lgkmcnt(6)
    v_mfma_f32_16x16x32_bf16 v[88:91], v[172:175], v[32:35], v[88:91]
    v_mfma_f32_16x16x32_bf16 v[92:95], v[172:175], v[40:43], v[92:95]
    ds_read_b64_tr_b16 v[188:189], v235 offset:16384
    ds_read_b64_tr_b16 v[190:191], v235 offset:20480
    v_exp_f32 v59, v59
    v_add_f32 v247, v247, v57
    v_fma_f32 v61, v61, s26, v245
    v_exp_f32 v60, v60
    s_waitcnt lgkmcnt(6)
    v_mfma_f32_16x16x32_bf16 v[96:99], v[176:179], v[32:35], v[96:99]
    v_mfma_f32_16x16x32_bf16 v[100:103], v[176:179], v[40:43], v[100:103]
    ds_read_b64_tr_b16 v[160:161], v228 offset:24576
    ds_read_b64_tr_b16 v[162:163], v228 offset:28672
    v_add_f32 v247, v247, v58
    v_cvt_pk_bf16_f32 v56, v56, v57
    v_fma_f32 v62, v62, s26, v245
    v_exp_f32 v61, v61
    v_add_f32 v247, v247, v59
    s_waitcnt lgkmcnt(6)
    v_mfma_f32_16x16x32_bf16 v[104:107], v[180:183], v[32:35], v[104:107]
    v_mfma_f32_16x16x32_bf16 v[108:111], v[180:183], v[40:43], v[108:111]
    ds_read_b64_tr_b16 v[164:165], v229 offset:24576
    ds_read_b64_tr_b16 v[166:167], v229 offset:28672
    buffer_load_dwordx4 v237, s[8:11], s21 offen offset:1024 nt lds
    v_fma_f32 v63, v63, s26, v245
    v_exp_f32 v62, v62
    v_add_f32 v247, v247, v60
    v_cvt_pk_bf16_f32 v57, v58, v59
    s_waitcnt lgkmcnt(6)
    v_mfma_f32_16x16x32_bf16 v[112:115], v[184:187], v[32:35], v[112:115]
    v_mfma_f32_16x16x32_bf16 v[116:119], v[184:187], v[40:43], v[116:119]
    ds_read_b64_tr_b16 v[168:169], v230 offset:24576
    ds_read_b64_tr_b16 v[170:171], v230 offset:28672
    v_exp_f32 v63, v63
    v_add_f32 v247, v247, v61
    v_add_f32 v247, v247, v62
    v_cvt_pk_bf16_f32 v58, v60, v61
    s_waitcnt lgkmcnt(6)
    v_mfma_f32_16x16x32_bf16 v[120:123], v[188:191], v[32:35], v[120:123]
    v_mfma_f32_16x16x32_bf16 v[124:127], v[188:191], v[40:43], v[124:127]
    ds_read_b64_tr_b16 v[172:173], v231 offset:24576
    ds_read_b64_tr_b16 v[174:175], v231 offset:28672
    v_add_f32 v247, v247, v63
    v_cvt_pk_bf16_f32 v59, v62, v63
    v_max3_f32 v242, v242, v16, v17
    v_max3_f32 v243, v243, v24, v25
    v_max3_f32 v242, v242, v18, v19
    s_waitcnt lgkmcnt(6)
    v_mfma_f32_16x16x32_bf16 v[64:67], v[160:163], v[48:51], v[64:67]
    v_mfma_f32_16x16x32_bf16 v[68:71], v[160:163], v[56:59], v[68:71]
    ds_read_b64_tr_b16 v[176:177], v232 offset:24576
    ds_read_b64_tr_b16 v[178:179], v232 offset:28672
    v_max3_f32 v243, v243, v26, v27
    v_max3_f32 v242, v242, v20, v21
    v_max3_f32 v243, v243, v28, v29
    v_max3_f32 v242, v242, v22, v23
    s_waitcnt lgkmcnt(6)
    v_mfma_f32_16x16x32_bf16 v[72:75], v[164:167], v[48:51], v[72:75]
    v_mfma_f32_16x16x32_bf16 v[76:79], v[164:167], v[56:59], v[76:79]
    ds_read_b64_tr_b16 v[180:181], v233 offset:24576
    ds_read_b64_tr_b16 v[182:183], v233 offset:28672
    buffer_store_dwordx4 v[200:203], v241, s[16:19], s33 offen offset:2048 sc1
    v_max3_f32 v243, v243, v30, v31
    v_fma_f32 v250, v242, s26, v244
    v_fma_f32 v251, v243, s26, v245
    v_max_f32 v250, v250, v251
    v_cmp_lt_f32 vcc, s35, v250
    s_cbranch_vccnz L_rare2
L_back2:
    s_waitcnt lgkmcnt(6)
    v_mfma_f32_16x16x32_bf16 v[80:83], v[168:171], v[48:51], v[80:83]
    v_mfma_f32_16x16x32_bf16 v[84:87], v[168:171], v[56:59], v[84:87]
    ds_read_b64_tr_b16 v[184:185], v234 offset:24576
    ds_read_b64_tr_b16 v[186:187], v234 offset:28672
    v_fma_f32 v0, v0, s26, v244
    v_fma_f32 v1, v1, s26, v244
    v_exp_f32 v0, v0
    v_fma_f32 v2, v2, s26, v244
    s_waitcnt lgkmcnt(6)
    v_mfma_f32_16x16x32_bf16 v[88:91], v[172:175], v[48:51], v[88:91]
    v_mfma_f32_16x16x32_bf16 v[92:95], v[172:175], v[56:59], v[92:95]
    ds_read_b64_tr_b16 v[188:189], v235 offset:24576
    ds_read_b64_tr_b16 v[190:191], v235 offset:28672
    v_exp_f32 v1, v1
    v_fma_f32 v3, v3, s26, v244
    v_exp_f32 v2, v2
    v_add_f32 v246, v246, v0
    s_waitcnt lgkmcnt(6)
    v_mfma_f32_16x16x32_bf16 v[96:99], v[176:179], v[48:51], v[96:99]
    v_mfma_f32_16x16x32_bf16 v[100:103], v[176:179], v[56:59], v[100:103]
    s_waitcnt vmcnt(13) lgkmcnt(0)
    s_barrier
    ds_read_b128 v[160:163], v224 offset:32768
    v_fma_f32 v4, v4, s26, v244
    v_exp_f32 v3, v3
    v_add_f32 v246, v246, v1
    v_fma_f32 v5, v5, s26, v244
    v_exp_f32 v4, v4
    v_mfma_f32_16x16x32_bf16 v[104:107], v[180:183], v[48:51], v[104:107]
    v_mfma_f32_16x16x32_bf16 v[108:111], v[180:183], v[56:59], v[108:111]
    ds_read_b128 v[164:167], v225 offset:32768
    buffer_store_dwordx4 v[204:207], v253, s[16:19], s33 offen offset:3072 sc1
    v_add_f32 v246, v246, v2
    v_cvt_pk_bf16_f32 v0, v0, v1
    v_fma_f32 v6, v6, s26, v244
    v_exp_f32 v5, v5
    v_mfma_f32_16x16x32_bf16 v[112:115], v[184:187], v[48:51], v[112:115]
    v_mfma_f32_16x16x32_bf16 v[116:119], v[184:187], v[56:59], v[116:119]
    ds_read_b128 v[168:171], v226 offset:32768
    v_add_f32 v246, v246, v3
    v_fma_f32 v7, v7, s26, v244
    v_exp_f32 v6, v6
    v_add_f32 v246, v246, v4
    v_cvt_pk_bf16_f32 v1, v2, v3
    v_mfma_f32_16x16x32_bf16 v[120:123], v[188:191], v[48:51], v[120:123]
    v_mfma_f32_16x16x32_bf16 v[124:127], v[188:191], v[56:59], v[124:127]
    ds_read_b128 v[172:175], v227 offset:32768
    v_exp_f32 v7, v7
    v_add_f32 v246, v246, v5
    v_add_f32 v246, v246, v6
    v_cvt_pk_bf16_f32 v2, v4, v5
    s_waitcnt lgkmcnt(3)
    v_mfma_f32_16x16x32_bf16 v[32:35], v[160:163], v[128:131], 0
    v_mfma_f32_16x16x32_bf16 v[40:43], v[160:163], v[144:147], 0
    ds_read_b128 v[176:179], v224 offset:36864
    v_add_f32 v246, v246, v7
    v_cvt_pk_bf16_f32 v3, v6, v7
    v_fma_f32 v8, v8, s26, v245
    v_fma_f32 v9, v9, s26, v245
    s_waitcnt lgkmcnt(3)
    v_mfma_f32_16x16x32_bf16 v[32:35], v[164:167], v[132:135], v[32:35]
    v_mfma_f32_16x16x32_bf16 v[40:43], v[164:167], v[148:151], v[40:43]
    ds_read_b128 v[180:183], v225 offset:36864
    s_add_u32 m0, s23, 16384
    s_add_u32 s27, s20, 49152
    buffer_load_dwordx4 v238, s[12:15], s27 offen nt lds
    v_exp_f32 v8, v8
    v_fma_f32 v10, v10, s26, v245
    v_exp_f32 v9, v9
    v_fma_f32 v11, v11, s26, v245
    v_exp_f32 v10, v10
    s_waitcnt lgkmcnt(3)
    v_mfma_f32_16x16x32_bf16 v[32:35], v[168:171], v[136:139], v[32:35]
    v_mfma_f32_16x16x32_bf16 v[40:43], v[168:171], v[152:155], v[40:43]
    ds_read_b128 v[184:187], v226 offset:36864
    v_add_f32 v247, v247, v8
    v_fma_f32 v12, v12, s26, v245
    v_exp_f32 v11, v11
    v_add_f32 v247, v247, v9
    s_waitcnt lgkmcnt(3)
    v_mfma_f32_16x16x32_bf16 v[32:35], v[172:175], v[140:143], v[32:35]
    v_mfma_f32_16x16x32_bf16 v[40:43], v[172:175], v[156:159], v[40:43]
    ds_read_b128 v[188:191], v227 offset:36864
    v_fma_f32 v13, v13, s26, v245
    v_exp_f32 v12, v12
    v_add_f32 v247, v247, v10
    v_cvt_pk_bf16_f32 v8, v8, v9
    v_fma_f32 v14, v14, s26, v245
    s_waitcnt lgkmcnt(3)
    v_mfma_f32_16x16x32_bf16 v[36:39], v[176:179], v[128:131], 0
    v_mfma_f32_16x16x32_bf16 v[44:47], v[176:179], v[144:147], 0
    ds_read_b128 v[160:163], v224 offset:40960
    v_exp_f32 v13, v13
    v_add_f32 v247, v247, v11
    v_fma_f32 v15, v15, s26, v245
    v_exp_f32 v14, v14
    s_waitcnt lgkmcnt(3)
    v_mfma_f32_16x16x32_bf16 v[36:39], v[180:183], v[132:135], v[36:39]
    v_mfma_f32_16x16x32_bf16 v[44:47], v[180:183], v[148:151], v[44:47]
    ds_read_b128 v[164:167], v225 offset:40960
    buffer_load_dwordx4 v239, s[12:15], s27 offen offset:1024 nt lds
    v_add_f32 v247, v247, v12
    v_cvt_pk_bf16_f32 v9, v10, v11
    v_exp_f32 v15, v15
    v_add_f32 v247, v247, v13
    s_waitcnt lgkmcnt(3)
    v_mfma_f32_16x16x32_bf16 v[36:39], v[184:187], v[136:139], v[36:39]
    v_mfma_f32_16x16x32_bf16 v[44:47], v[184:187], v[152:155], v[44:47]
    ds_read_b128 v[168:171], v226 offset:40960
    v_add_f32 v247, v247, v14
    v_cvt_pk_bf16_f32 v10, v12, v13
    v_add_f32 v247, v247, v15
    v_cvt_pk_bf16_f32 v11, v14, v15
    v_fma_f32 v16, v16, s26, v244
    s_waitcnt lgkmcnt(3)
    v_mfma_f32_16x16x32_bf16 v[36:39], v[188:191], v[140:143], v[36:39]
    v_mfma_f32_16x16x32_bf16 v[44:47], v[188:191], v[156:159], v[44:47]
    ds_read_b128 v[172:175], v227 offset:40960
    v_fma_f32 v17, v17, s26, v244
    v_exp_f32 v16, v16
    v_fma_f32 v18, v18, s26, v244
    v_exp_f32 v17, v17
    s_waitcnt lgkmcnt(3)
    v_mfma_f32_16x16x32_bf16 v[48:51], v[160:163], v[128:131], 0
    v_mfma_f32_16x16x32_bf16 v[56:59], v[160:163], v[144:147], 0
    ds_read_b128 v[176:179], v224 offset:45056
    v_fma_f32 v19, v19, s26, v244
    v_exp_f32 v18, v18
    v_add_f32 v246, v246, v16
    v_fma_f32 v20, v20, s26, v244
    v_exp_f32 v19, v19
    s_waitcnt lgkmcnt(3)
    v_mfma_f32_16x16x32_bf16 v[48:51], v[164:167], v[132:135], v[48:51]
    v_mfma_f32_16x16x32_bf16 v[56:59], v[164:167], v[148:151], v[56:59]
    ds_read_b128 v[180:183], v225 offset:45056
    buffer_store_dwordx4 v[208:211], v241, s[16:19], s34 offen sc1
    v_add_f32 v246, v246, v17
    v_fma_f32 v21, v21, s26, v244
    v_exp_f32 v20, v20
    v_add_f32 v246, v246, v18
    s_waitcnt lgkmcnt(3)
    v_mfma_f32_16x16x32_bf16 v[48:51], v[168:171], v[136:139], v[48:51]
    v_mfma_f32_16x16x32_bf16 v[56:59], v[168:171], v[152:155], v[56:59]
    ds_read_b128 v[184:187], v226 offset:45056
    v_cvt_pk_bf16_f32 v16, v16, v17
    v_fma_f32 v22, v22, s26, v244
    v_exp_f32 v21, v21
    v_add_f32 v246, v246, v19
    s_waitcnt lgkmcnt(3)
    v_mfma_f32_16x16x32_bf16 v[48:51], v[172:175], v[140:143], v[48:51]
    v_mfma_f32_16x16x32_bf16 v[56:59], v[172:175], v[156:159], v[56:59]
    ds_read_b128 v[188:191], v227 offset:45056
    v_fma_f32 v23, v23, s26, v244
    v_exp_f32 v22, v22
    v_add_f32 v246, v246, v20
    v_cvt_pk_bf16_f32 v17, v18, v19
    v_exp_f32 v23, v23
    s_waitcnt lgkmcnt(3)
    v_mfma_f32_16x16x32_bf16 v[52:55], v[176:179], v[128:131], 0
    v_mfma_f32_16x16x32_bf16 v[60:63], v[176:179], v[144:147], 0
    s_waitcnt vmcnt(9) lgkmcnt(0)
    s_barrier
    ds_read_b64_tr_b16 v[160:161], v228 offset:49152
    ds_read_b64_tr_b16 v[162:163], v228 offset:53248
    v_add_f32 v246, v246, v21
    v_add_f32 v246, v246, v22
    v_cvt_pk_bf16_f32 v18, v20, v21
    v_add_f32 v246, v246, v23
    v_mfma_f32_16x16x32_bf16 v[52:55], v[180:183], v[132:135], v[52:55]
    v_mfma_f32_16x16x32_bf16 v[60:63], v[180:183], v[148:151], v[60:63]
    ds_read_b64_tr_b16 v[164:165], v229 offset:49152
    ds_read_b64_tr_b16 v[166:167], v229 offset:53248
    buffer_store_dwordx4 v[212:215], v253, s[16:19], s34 offen offset:1024 sc1
    v_cvt_pk_bf16_f32 v19, v22, v23
    v_max_f32 v242, v32, v33
    v_max_f32 v243, v40, v41
    v_max3_f32 v242, v242, v34, v35
    v_max3_f32 v243, v243, v42, v43
    v_mfma_f32_16x16x32_bf16 v[52:55], v[184:187], v[136:139], v[52:55]
    v_mfma_f32_16x16x32_bf16 v[60:63], v[184:187], v[152:155], v[60:63]
    ds_read_b64_tr_b16 v[168:169], v230 offset:49152
    ds_read_b64_tr_b16 v[170:171], v230 offset:53248
    v_max3_f32 v242, v242, v36, v37
    v_max3_f32 v243, v243, v44, v45
    v_max3_f32 v242, v242, v38, v39
    v_max3_f32 v243, v243, v46, v47
    s_add_u32 s46, s21, 16777216
    v_mfma_f32_16x16x32_bf16 v[52:55], v[188:191], v[140:143], v[52:55]
    v_mfma_f32_16x16x32_bf16 v[60:63], v[188:191], v[156:159], v[60:63]
    ds_read_b64_tr_b16 v[172:173], v231 offset:49152
    ds_read_b64_tr_b16 v[174:175], v231 offset:53248
    v_fma_f32 v24, v24, s26, v245
    v_fma_f32 v25, v25, s26, v245
    v_exp_f32 v24, v24
    v_fma_f32 v26, v26, s26, v245
    s_waitcnt lgkmcnt(6)
    v_mfma_f32_16x16x32_bf16 v[64:67], v[160:163], v[0:3], v[64:67]
    v_mfma_f32_16x16x32_bf16 v[68:71], v[160:163], v[8:11], v[68:71]
    ds_read_b64_tr_b16 v[176:177], v232 offset:49152
    ds_read_b64_tr_b16 v[178:179], v232 offset:53248
    v_exp_f32 v25, v25
    v_fma_f32 v27, v27, s26, v245
    v_exp_f32 v26, v26
    v_add_f32 v247, v247, v24
    v_fma_f32 v28, v28, s26, v245
    s_waitcnt lgkmcnt(6)
    v_mfma_f32_16x16x32_bf16 v[72:75], v[164:167], v[0:3], v[72:75]
    v_mfma_f32_16x16x32_bf16 v[76:79], v[164:167], v[8:11], v[76:79]
    ds_read_b64_tr_b16 v[180:181], v233 offset:49152
    ds_read_b64_tr_b16 v[182:183], v233 offset:53248
    s_add_u32 m0, s23, 32768
    s_add_u32 s27, s21, 16384
    buffer_load_dwordx4 v236, s[8:11], s27 offen nt lds
    v_exp_f32 v27, v27
    v_add_f32 v247, v247, v25
    v_fma_f32 v29, v29, s26, v245
    v_exp_f32 v28, v28
    v_add_u32 v192, s24, v224
    s_waitcnt lgkmcnt(6)
    v_mfma_f32_16x16x32_bf16 v[80:83], v[168:171], v[0:3], v[80:83]
    v_mfma_f32_16x16x32_bf16 v[84:87], v[168:171], v[8:11], v[84:87]
    ds_read_b64_tr_b16 v[184:185], v234 offset:49152
    ds_read_b64_tr_b16 v[186:187], v234 offset:53248
    v_add_f32 v247, v247, v26
    v_cvt_pk_bf16_f32 v24, v24, v25
    v_fma_f32 v30, v30, s26, v245
    v_exp_f32 v29, v29
    v_add_f32 v247, v247, v27
    v_add_u32 v193, s24, v225
    ds_read_b128 v[128:131], v192 offset:0
    s_waitcnt lgkmcnt(7)
    v_mfma_f32_16x16x32_bf16 v[88:91], v[172:175], v[0:3], v[88:91]
    v_mfma_f32_16x16x32_bf16 v[92:95], v[172:175], v[8:11], v[92:95]
    ds_read_b64_tr_b16 v[188:189], v235 offset:49152
    ds_read_b64_tr_b16 v[190:191], v235 offset:53248
    v_fma_f32 v31, v31, s26, v245
    v_exp_f32 v30, v30
    v_add_f32 v247, v247, v28
    v_cvt_pk_bf16_f32 v25, v26, v27
    v_add_u32 v194, s24, v226
    ds_read_b128 v[132:135], v193 offset:0
    s_waitcnt lgkmcnt(8)
    v_mfma_f32_16x16x32_bf16 v[96:99], v[176:179], v[0:3], v[96:99]
    v_mfma_f32_16x16x32_bf16 v[100:103], v[176:179], v[8:11], v[100:103]
    ds_read_b64_tr_b16 v[160:161], v228 offset:57344
    ds_read_b64_tr_b16 v[162:163], v228 offset:61440
    v_exp_f32 v31, v31
    v_add_f32 v247, v247, v29
    v_add_f32 v247, v247, v30
    v_cvt_pk_bf16_f32 v26, v28, v29
    v_add_u32 v195, s24, v227
    ds_read_b128 v[136:139], v194 offset:0
    s_waitcnt lgkmcnt(9)
    v_mfma_f32_16x16x32_bf16 v[104:107], v[180:183], v[0:3], v[104:107]
    v_mfma_f32_16x16x32_bf16 v[108:111], v[180:183], v[8:11], v[108:111]
    ds_read_b64_tr_b16 v[164:165], v229 offset:57344
    ds_read_b64_tr_b16 v[166:167], v229 offset:61440
    buffer_load_dwordx4 v237, s[8:11], s27 offen offset:1024 nt lds
    v_add_f32 v247, v247, v31
    v_cvt_pk_bf16_f32 v27, v30, v31
    v_max3_f32 v242, v242, v48, v49
    v_max3_f32 v243, v243, v56, v57
    v_max3_f32 v242, v242, v50, v51
    ds_read_b128 v[140:143], v195 offset:0
    s_waitcnt lgkmcnt(10)
    v_mfma_f32_16x16x32_bf16 v[112:115], v[184:187], v[0:3], v[112:115]
    v_mfma_f32_16x16x32_bf16 v[116:119], v[184:187], v[8:11], v[116:119]
    ds_read_b64_tr_b16 v[168:169], v230 offset:57344
    ds_read_b64_tr_b16 v[170:171], v230 offset:61440
    v_max3_f32 v243, v243, v58, v59
    v_max3_f32 v242, v242, v52, v53
    v_max3_f32 v243, v243, v60, v61
    v_max3_f32 v242, v242, v54, v55
    ds_read_b128 v[144:147], v192 offset:4096
    s_waitcnt lgkmcnt(10)
    v_mfma_f32_16x16x32_bf16 v[120:123], v[188:191], v[0:3], v[120:123]
    v_mfma_f32_16x16x32_bf16 v[124:127], v[188:191], v[8:11], v[124:127]
    ds_read_b64_tr_b16 v[172:173], v231 offset:57344
    ds_read_b64_tr_b16 v[174:175], v231 offset:61440
    v_max3_f32 v243, v243, v62, v63
    v_fma_f32 v250, v242, s26, v244
    v_fma_f32 v251, v243, s26, v245
    v_max_f32 v250, v250, v251
    v_cmp_lt_f32 vcc, s35, v250
    s_cbranch_vccnz L_rare3
L_back3:
    ds_read_b128 v[148:151], v193 offset:4096
    s_waitcnt lgkmcnt(10)
    v_mfma_f32_16x16x32_bf16 v[64:67], v[160:163], v[16:19], v[64:67]
    v_mfma_f32_16x16x32_bf16 v[68:71], v[160:163], v[24:27], v[68:71]
    ds_read_b64_tr_b16 v[176:177], v232 offset:57344
    ds_read_b64_tr_b16 v[178:179], v232 offset:61440
    v_fma_f32 v32, v32, s26, v244
    v_fma_f32 v33, v33, s26, v244
    v_exp_f32 v32, v32
    v_fma_f32 v34, v34, s26, v244
    ds_read_b128 v[152:155], v194 offset:4096
    s_waitcnt lgkmcnt(10)
    v_mfma_f32_16x16x32_bf16 v[72:75], v[164:167], v[16:19], v[72:75]
    v_mfma_f32_16x16x32_bf16 v[76:79], v[164:167], v[24:27], v[76:79]
    ds_read_b64_tr_b16 v[180:181], v233 offset:57344
    ds_read_b64_tr_b16 v[182:183], v233 offset:61440
    buffer_store_dwordx4 v[216:219], v241, s[16:19], s34 offen offset:2048 sc1
    v_exp_f32 v33, v33
    v_fma_f32 v35, v35, s26, v244
    v_exp_f32 v34, v34
    v_add_f32 v246, v246, v32
    ds_read_b128 v[156:159], v195 offset:4096
    s_waitcnt lgkmcnt(10)
    v_mfma_f32_16x16x32_bf16 v[80:83], v[168:171], v[16:19], v[80:83]
    v_mfma_f32_16x16x32_bf16 v[84:87], v[168:171], v[24:27], v[84:87]
    ds_read_b64_tr_b16 v[184:185], v234 offset:57344
    ds_read_b64_tr_b16 v[186:187], v234 offset:61440
    v_fma_f32 v36, v36, s26, v244
    v_exp_f32 v35, v35
    v_add_f32 v246, v246, v33
    v_fma_f32 v37, v37, s26, v244
    v_exp_f32 v36, v36
    s_waitcnt lgkmcnt(9)
    v_mfma_f32_16x16x32_bf16 v[88:91], v[172:175], v[16:19], v[88:91]
    v_mfma_f32_16x16x32_bf16 v[92:95], v[172:175], v[24:27], v[92:95]
    ds_read_b64_tr_b16 v[188:189], v235 offset:57344
    ds_read_b64_tr_b16 v[190:191], v235 offset:61440
    v_add_f32 v246, v246, v34
    v_cvt_pk_bf16_f32 v32, v32, v33
    v_fma_f32 v38, v38, s26, v244
    v_exp_f32 v37, v37
    s_waitcnt lgkmcnt(8)
    v_mfma_f32_16x16x32_bf16 v[96:99], v[176:179], v[16:19], v[96:99]
    v_mfma_f32_16x16x32_bf16 v[100:103], v[176:179], v[24:27], v[100:103]
    s_waitcnt vmcnt(9) lgkmcnt(0)
    s_barrier
    ds_read_b128 v[160:163], v224 offset:0
    v_add_f32 v246, v246, v35
    v_fma_f32 v39, v39, s26, v244
    v_exp_f32 v38, v38
    v_add_f32 v246, v246, v36
    v_cvt_pk_bf16_f32 v33, v34, v35
    v_mfma_f32_16x16x32_bf16 v[104:107], v[180:183], v[16:19], v[104:107]
    v_mfma_f32_16x16x32_bf16 v[108:111], v[180:183], v[24:27], v[108:111]
    ds_read_b128 v[164:167], v225 offset:0
    buffer_store_dwordx4 v[220:223], v253, s[16:19], s34 offen offset:3072 sc1
    v_exp_f32 v39, v39
    v_add_f32 v246, v246, v37
    v_add_f32 v246, v246, v38
    v_cvt_pk_bf16_f32 v34, v36, v37
    v_mfma_f32_16x16x32_bf16 v[112:115], v[184:187], v[16:19], v[112:115]
    v_mfma_f32_16x16x32_bf16 v[116:119], v[184:187], v[24:27], v[116:119]
    ds_read_b128 v[168:171], v226 offset:0
    v_add_f32 v246, v246, v39
    v_cvt_pk_bf16_f32 v35, v38, v39
    v_mfma_f32_16x16x32_bf16 v[120:123], v[188:191], v[16:19], v[120:123]
    v_mfma_f32_16x16x32_bf16 v[124:127], v[188:191], v[24:27], v[124:127]
    ds_read_b128 v[172:175], v227 offset:0
    s_xor_b32 s22, s22, 0x10000
    s_xor_b32 s23, s23, 0x10000
    s_sub_u32 s24, s32, s24
    s_mov_b32 s33, s20
    s_add_u32 s34, s20, 4096
    s_mov_b32 s18, s29
    s_mov_b32 s20, s21
    s_mov_b32 s21, s46
    s_cmp_lt_u32 s21, 134217728
    s_cbranch_scc1 L_loop
    s_waitcnt lgkmcnt(2)
    v_mfma_f32_16x16x32_bf16 v[0:3], v[160:163], v[128:131], 0
    ds_read_b128 v[176:179], v224 offset:4096
    v_fma_f32 v40, v40, s26, v245
    v_fma_f32 v41, v41, s26, v245
    v_mfma_f32_16x16x32_bf16 v[8:11], v[160:163], v[144:147], 0
    v_exp_f32 v40, v40
    v_fma_f32 v42, v42, s26, v245
    v_exp_f32 v41, v41
    v_mfma_f32_16x16x32_bf16 v[0:3], v[164:167], v[132:135], v[0:3]
    ds_read_b128 v[180:183], v225 offset:4096
    s_add_u32 m0, s22, 49152
    s_nop 0
    buffer_load_dwordx4 v238, s[12:15], s20 offen nt lds
    v_fma_f32 v43, v43, s26, v245
    v_exp_f32 v42, v42
    v_mfma_f32_16x16x32_bf16 v[8:11], v[164:167], v[148:151], v[8:11]
    v_add_f32 v247, v247, v40
    v_fma_f32 v44, v44, s26, v245
    v_exp_f32 v43, v43
    s_waitcnt lgkmcnt(2)
    v_mfma_f32_16x16x32_bf16 v[0:3], v[168:171], v[136:139], v[0:3]
    ds_read_b128 v[184:187], v226 offset:4096
    v_add_f32 v247, v247, v41
    v_fma_f32 v45, v45, s26, v245
    v_mfma_f32_16x16x32_bf16 v[8:11], v[168:171], v[152:155], v[8:11]
    v_exp_f32 v44, v44
    v_add_f32 v247, v247, v42
    v_cvt_pk_bf16_f32 v40, v40, v41
    v_mfma_f32_16x16x32_bf16 v[0:3], v[172:175], v[140:143], v[0:3]
    ds_read_b128 v[188:191], v227 offset:4096
    v_fma_f32 v46, v46, s26, v245
    v_exp_f32 v45, v45
    v_mfma_f32_16x16x32_bf16 v[8:11], v[172:175], v[156:159], v[8:11]
    v_add_f32 v247, v247, v43
    v_fma_f32 v47, v47, s26, v245
    v_exp_f32 v46, v46
    v_add_f32 v247, v247, v44
    s_waitcnt lgkmcnt(2)
    v_mfma_f32_16x16x32_bf16 v[4:7], v[176:179], v[128:131], 0
    ds_read_b128 v[160:163], v224 offset:8192
    v_cvt_pk_bf16_f32 v41, v42, v43
    v_exp_f32 v47, v47
    v_mfma_f32_16x16x32_bf16 v[12:15], v[176:179], v[144:147], 0
    v_add_f32 v247, v247, v45
    v_add_f32 v247, v247, v46
    v_cvt_pk_bf16_f32 v42, v44, v45
    v_mfma_f32_16x16x32_bf16 v[4:7], v[180:183], v[132:135], v[4:7]
    ds_read_b128 v[164:167], v225 offset:8192
    buffer_load_dwordx4 v239, s[12:15], s20 offen offset:1024 nt lds
    v_add_f32 v247, v247, v47
    v_cvt_pk_bf16_f32 v43, v46, v47
    v_mfma_f32_16x16x32_bf16 v[12:15], v[180:183], v[148:151], v[12:15]
    v_fma_f32 v48, v48, s26, v244
    v_fma_f32 v49, v49, s26, v244
    v_exp_f32 v48, v48
    s_waitcnt lgkmcnt(2)
    v_mfma_f32_16x16x32_bf16 v[4:7], v[184:187], v[136:139], v[4:7]
    ds_read_b128 v[168:171], v226 offset:8192
    v_fma_f32 v50, v50, s26, v244
    v_exp_f32 v49, v49
    v_mfma_f32_16x16x32_bf16 v[12:15], v[184:187], v[152:155], v[12:15]
    v_fma_f32 v51, v51, s26, v244
    v_exp_f32 v50, v50
    v_add_f32 v246, v246, v48
    v_fma_f32 v52, v52, s26, v244
    v_mfma_f32_16x16x32_bf16 v[4:7], v[188:191], v[140:143], v[4:7]
    ds_read_b128 v[172:175], v227 offset:8192
    v_exp_f32 v51, v51
    v_add_f32 v246, v246, v49
    v_mfma_f32_16x16x32_bf16 v[12:15], v[188:191], v[156:159], v[12:15]
    v_fma_f32 v53, v53, s26, v244
    v_exp_f32 v52, v52
    v_add_f32 v246, v246, v50
    s_waitcnt lgkmcnt(2)
    v_mfma_f32_16x16x32_bf16 v[16:19], v[160:163], v[128:131], 0
    ds_read_b128 v[176:179], v224 offset:12288
    v_cvt_pk_bf16_f32 v48, v48, v49
    v_fma_f32 v54, v54, s26, v244
    v_mfma_f32_16x16x32_bf16 v[24:27], v[160:163], v[144:147], 0
    v_exp_f32 v53, v53
    v_add_f32 v246, v246, v51
    v_fma_f32 v55, v55, s26, v244
    v_mfma_f32_16x16x32_bf16 v[16:19], v[164:167], v[132:135], v[16:19]
    ds_read_b128 v[180:183], v225 offset:12288
    s_mov_b32 m0, s23
    s_add_u32 s27, s20, 32768
    buffer_load_dwordx4 v236, s[8:11], s27 offen nt lds
    v_exp_f32 v54, v54
    v_add_f32 v246, v246, v52
    v_mfma_f32_16x16x32_bf16 v[24:27], v[164:167], v[148:151], v[24:27]
    v_cvt_pk_bf16_f32 v49, v50, v51
    v_exp_f32 v55, v55
    v_add_f32 v246, v246, v53
    v_add_f32 v246, v246, v54
    s_waitcnt lgkmcnt(2)
    v_mfma_f32_16x16x32_bf16 v[16:19], v[168:171], v[136:139], v[16:19]
    ds_read_b128 v[184:187], v226 offset:12288
    v_cvt_pk_bf16_f32 v50, v52, v53
    v_add_f32 v246, v246, v55
    v_mfma_f32_16x16x32_bf16 v[24:27], v[168:171], v[152:155], v[24:27]
    v_cvt_pk_bf16_f32 v51, v54, v55
    v_fma_f32 v56, v56, s26, v245
    v_fma_f32 v57, v57, s26, v245
    v_mfma_f32_16x16x32_bf16 v[16:19], v[172:175], v[140:143], v[16:19]
    ds_read_b128 v[188:191], v227 offset:12288
    v_exp_f32 v56, v56
    v_fma_f32 v58, v58, s26, v245
    v_mfma_f32_16x16x32_bf16 v[24:27], v[172:175], v[156:159], v[24:27]
    v_exp_f32 v57, v57
    v_fma_f32 v59, v59, s26, v245
    v_exp_f32 v58, v58
    s_waitcnt lgkmcnt(2)
    v_mfma_f32_16x16x32_bf16 v[20:23], v[176:179], v[128:131], 0
    s_waitcnt vmcnt(9) lgkmcnt(0)
    s_barrier
    ds_read_b64_tr_b16 v[160:161], v228 offset:16384
    ds_read_b64_tr_b16 v[162:163], v228 offset:20480
    v_add_f32 v247, v247, v56
    v_fma_f32 v60, v60, s26, v245
    v_mfma_f32_16x16x32_bf16 v[28:31], v[176:179], v[144:147], 0
    v_exp_f32 v59, v59
    v_add_f32 v247, v247, v57
    v_fma_f32 v61, v61, s26, v245
    v_mfma_f32_16x16x32_bf16 v[20:23], v[180:183], v[132:135], v[20:23]
    ds_read_b64_tr_b16 v[164:165], v228 offset:24576
    ds_read_b64_tr_b16 v[166:167], v228 offset:28672
    buffer_load_dwordx4 v237, s[8:11], s27 offen offset:1024 nt lds
    v_exp_f32 v60, v60
    v_add_f32 v247, v247, v58
    v_mfma_f32_16x16x32_bf16 v[28:31], v[180:183], v[148:151], v[28:31]
    v_cvt_pk_bf16_f32 v56, v56, v57
    v_fma_f32 v62, v62, s26, v245
    v_exp_f32 v61, v61
    v_add_f32 v247, v247, v59
    v_mfma_f32_16x16x32_bf16 v[20:23], v[184:187], v[136:139], v[20:23]
    ds_read_b64_tr_b16 v[168:169], v229 offset:16384
    ds_read_b64_tr_b16 v[170:171], v229 offset:20480
    v_fma_f32 v63, v63, s26, v245
    v_exp_f32 v62, v62
    v_mfma_f32_16x16x32_bf16 v[28:31], v[184:187], v[152:155], v[28:31]
    v_add_f32 v247, v247, v60
    v_cvt_pk_bf16_f32 v57, v58, v59
    v_exp_f32 v63, v63
    v_mfma_f32_16x16x32_bf16 v[20:23], v[188:191], v[140:143], v[20:23]
    ds_read_b64_tr_b16 v[172:173], v229 offset:24576
    ds_read_b64_tr_b16 v[174:175], v229 offset:28672
    v_add_f32 v247, v247, v61
    v_add_f32 v247, v247, v62
    v_mfma_f32_16x16x32_bf16 v[28:31], v[188:191], v[156:159], v[28:31]
    v_cvt_pk_bf16_f32 v58, v60, v61
    v_add_f32 v247, v247, v63
    v_cvt_pk_bf16_f32 v59, v62, v63
    s_waitcnt lgkmcnt(4)
    v_mfma_f32_16x16x32_bf16 v[64:67], v[160:163], v[32:35], v[64:67]
    ds_read_b64_tr_b16 v[176:177], v230 offset:16384
    ds_read_b64_tr_b16 v[178:179], v230 offset:20480
    v_max_f32 v242, v0, v1
    v_max_f32 v243, v8, v9
    v_mfma_f32_16x16x32_bf16 v[68:71], v[160:163], v[40:43], v[68:71]
    v_max3_f32 v242, v242, v2, v3
    v_max3_f32 v243, v243, v10, v11
    v_max3_f32 v242, v242, v4, v5
    v_max3_f32 v243, v243, v12, v13
    v_mfma_f32_16x16x32_bf16 v[64:67], v[164:167], v[48:51], v[64:67]
    ds_read_b64_tr_b16 v[180:181], v230 offset:24576
    ds_read_b64_tr_b16 v[182:183], v230 offset:28672
    s_add_u32 m0, s23, 16384
    s_add_u32 s27, s20, 16384
    buffer_load_dwordx4 v238, s[12:15], s27 offen nt lds
    v_mov_b32 v250, v246
    v_mov_b32 v251, v247
    v_mfma_f32_16x16x32_bf16 v[68:71], v[164:167], v[56:59], v[68:71]
    v_max3_f32 v242, v242, v6, v7
    v_permlane16_swap_b32 v250, v246
    v_permlane16_swap_b32 v251, v247
    s_waitcnt lgkmcnt(4)
    v_mfma_f32_16x16x32_bf16 v[72:75], v[168:171], v[32:35], v[72:75]
    ds_read_b64_tr_b16 v[184:185], v231 offset:16384
    ds_read_b64_tr_b16 v[186:187], v231 offset:20480
    v_add_f32 v246, v246, v250
    v_add_f32 v247, v247, v251
    v_mfma_f32_16x16x32_bf16 v[76:79], v[168:171], v[40:43], v[76:79]
    v_mov_b32 v250, v246
    v_mov_b32 v251, v247
    v_max3_f32 v243, v243, v14, v15
    v_permlane32_swap_b32 v250, v246
    v_permlane32_swap_b32 v251, v247
    v_mfma_f32_16x16x32_bf16 v[72:75], v[172:175], v[48:51], v[72:75]
    ds_read_b64_tr_b16 v[188:189], v231 offset:24576
    ds_read_b64_tr_b16 v[190:191], v231 offset:28672
    v_add_f32 v246, v246, v250
    v_add_f32 v247, v247, v251
    v_mfma_f32_16x16x32_bf16 v[76:79], v[172:175], v[56:59], v[76:79]
    v_rcp_f32 v248, v246
    v_rcp_f32 v249, v247
    v_max3_f32 v242, v242, v16, v17
    v_max3_f32 v243, v243, v24, v25
    v_max3_f32 v242, v242, v18, v19
    s_waitcnt lgkmcnt(4)
    v_mfma_f32_16x16x32_bf16 v[80:83], v[176:179], v[32:35], v[80:83]
    ds_read_b64_tr_b16 v[160:161], v232 offset:16384
    ds_read_b64_tr_b16 v[162:163], v232 offset:20480
    v_max3_f32 v243, v243, v26, v27
    v_max3_f32 v242, v242, v20, v21
    v_mfma_f32_16x16x32_bf16 v[84:87], v[176:179], v[40:43], v[84:87]
    v_max3_f32 v243, v243, v28, v29
    v_max3_f32 v242, v242, v22, v23
    v_max3_f32 v243, v243, v30, v31
    v_mov_b32 v250, v242
    v_mfma_f32_16x16x32_bf16 v[80:83], v[180:183], v[48:51], v[80:83]
    ds_read_b64_tr_b16 v[164:165], v232 offset:24576
    ds_read_b64_tr_b16 v[166:167], v232 offset:28672
    buffer_load_dwordx4 v239, s[12:15], s27 offen offset:1024 nt lds
    v_mov_b32 v251, v243
    v_mov_b32 v246, 0
    v_mfma_f32_16x16x32_bf16 v[84:87], v[180:183], v[56:59], v[84:87]
    v_permlane16_swap_b32 v250, v242
    v_permlane16_swap_b32 v251, v243
    v_max_f32 v242, v242, v250
    v_max_f32 v243, v243, v251
    v_mov_b32 v250, v242
    s_waitcnt lgkmcnt(4)
    v_mfma_f32_16x16x32_bf16 v[88:91], v[184:187], v[32:35], v[88:91]
    ds_read_b64_tr_b16 v[168:169], v233 offset:16384
    ds_read_b64_tr_b16 v[170:171], v233 offset:20480
    v_mov_b32 v251, v243
    v_mov_b32 v247, 0
    v_mfma_f32_16x16x32_bf16 v[92:95], v[184:187], v[40:43], v[92:95]
    v_permlane32_swap_b32 v250, v242
    v_permlane32_swap_b32 v251, v243
    v_max_f32 v242, v242, v250
    v_max_f32 v243, v243, v251
    v_mul_f32 v244, s31, v242
    v_mfma_f32_16x16x32_bf16 v[88:91], v[188:191], v[48:51], v[88:91]
    ds_read_b64_tr_b16 v[172:173], v233 offset:24576
    ds_read_b64_tr_b16 v[174:175], v233 offset:28672
    v_mul_f32 v245, s31, v243
    v_fma_f32 v0, v0, s26, v244
    v_mfma_f32_16x16x32_bf16 v[92:95], v[188:191], v[56:59], v[92:95]
    v_fma_f32 v1, v1, s26, v244
    v_exp_f32 v0, v0
    v_fma_f32 v2, v2, s26, v244
    v_exp_f32 v1, v1
    s_waitcnt lgkmcnt(4)
    v_mfma_f32_16x16x32_bf16 v[96:99], v[160:163], v[32:35], v[96:99]
    ds_read_b64_tr_b16 v[176:177], v234 offset:16384
    ds_read_b64_tr_b16 v[178:179], v234 offset:20480
    v_fma_f32 v3, v3, s26, v244
    v_exp_f32 v2, v2
    v_mfma_f32_16x16x32_bf16 v[100:103], v[160:163], v[40:43], v[100:103]
    v_add_f32 v246, v246, v0
    v_fma_f32 v4, v4, s26, v244
    v_exp_f32 v3, v3
    v_add_f32 v246, v246, v1
    v_fma_f32 v5, v5, s26, v244
    v_mfma_f32_16x16x32_bf16 v[96:99], v[164:167], v[48:51], v[96:99]
    ds_read_b64_tr_b16 v[180:181], v234 offset:24576
    ds_read_b64_tr_b16 v[182:183], v234 offset:28672
    v_exp_f32 v4, v4
    v_add_f32 v246, v246, v2
    v_mfma_f32_16x16x32_bf16 v[100:103], v[164:167], v[56:59], v[100:103]
    v_cvt_pk_bf16_f32 v0, v0, v1
    v_fma_f32 v6, v6, s26, v244
    v_exp_f32 v5, v5
    v_add_f32 v246, v246, v3
    v_fma_f32 v7, v7, s26, v244
    s_waitcnt lgkmcnt(4)
    v_mfma_f32_16x16x32_bf16 v[104:107], v[168:171], v[32:35], v[104:107]
    ds_read_b64_tr_b16 v[184:185], v235 offset:16384
    ds_read_b64_tr_b16 v[186:187], v235 offset:20480
    v_exp_f32 v6, v6
    v_add_f32 v246, v246, v4
    v_mfma_f32_16x16x32_bf16 v[108:111], v[168:171], v[40:43], v[108:111]
    v_cvt_pk_bf16_f32 v1, v2, v3
    v_exp_f32 v7, v7
    v_add_f32 v246, v246, v5
    v_add_f32 v246, v246, v6
    v_mfma_f32_16x16x32_bf16 v[104:107], v[172:175], v[48:51], v[104:107]
    ds_read_b64_tr_b16 v[188:189], v235 offset:24576
    ds_read_b64_tr_b16 v[190:191], v235 offset:28672
    v_cvt_pk_bf16_f32 v2, v4, v5
    v_add_f32 v246, v246, v7
    v_mfma_f32_16x16x32_bf16 v[108:111], v[172:175], v[56:59], v[108:111]
    v_cvt_pk_bf16_f32 v3, v6, v7
    v_fma_f32 v8, v8, s26, v245
    v_fma_f32 v9, v9, s26, v245
    v_exp_f32 v8, v8
    v_fma_f32 v10, v10, s26, v245
    s_waitcnt lgkmcnt(4)
    v_mfma_f32_16x16x32_bf16 v[112:115], v[176:179], v[32:35], v[112:115]
    s_waitcnt vmcnt(8) lgkmcnt(0)
    s_barrier
    ds_read_b128 v[160:163], v224 offset:32768
    v_exp_f32 v9, v9
    v_fma_f32 v11, v11, s26, v245
    v_mfma_f32_16x16x32_bf16 v[116:119], v[176:179], v[40:43], v[116:119]
    v_exp_f32 v10, v10
    v_add_f32 v247, v247, v8
    v_fma_f32 v12, v12, s26, v245
    v_exp_f32 v11, v11
    v_add_f32 v247, v247, v9
    v_mfma_f32_16x16x32_bf16 v[112:115], v[180:183], v[48:51], v[112:115]
    ds_read_b128 v[164:167], v225 offset:32768
    v_fma_f32 v13, v13, s26, v245
    v_mul_f32 v64, v64, v248
    v_mfma_f32_16x16x32_bf16 v[116:119], v[180:183], v[56:59], v[116:119]
    v_mul_f32 v65, v65, v248
    v_mul_f32 v66, v66, v248
    v_mul_f32 v67, v67, v248
    v_cvt_pk_bf16_f32 v192, v64, v65
    v_exp_f32 v12, v12
    v_mfma_f32_16x16x32_bf16 v[120:123], v[184:187], v[32:35], v[120:123]
    ds_read_b128 v[168:171], v226 offset:32768
    v_cvt_pk_bf16_f32 v193, v66, v67
    ds_write_b64 v252, v[192:193] offset:0
    v_mfma_f32_16x16x32_bf16 v[124:127], v[184:187], v[40:43], v[124:127]
    v_mul_f32 v68, v68, v249
    v_mul_f32 v69, v69, v249
    v_mul_f32 v70, v70, v249
    v_add_f32 v247, v247, v10
    v_mul_f32 v71, v71, v249
    v_mfma_f32_16x16x32_bf16 v[120:123], v[188:191], v[48:51], v[120:123]
    ds_read_b128 v[172:175], v227 offset:32768
    v_cvt_pk_bf16_f32 v208, v68, v69
    v_cvt_pk_bf16_f32 v209, v70, v71
    v_mfma_f32_16x16x32_bf16 v[124:127], v[188:191], v[56:59], v[124:127]
    v_mul_f32 v72, v72, v248
    v_mul_f32 v73, v73, v248
    v_cvt_pk_bf16_f32 v8, v8, v9
    v_mul_f32 v74, v74, v248
    v_mul_f32 v75, v75, v248
    s_waitcnt lgkmcnt(3)
    v_mfma_f32_16x16x32_bf16 v[32:35], v[160:163], v[128:131], 0
    ds_read_b128 v[176:179], v224 offset:36864
    v_cvt_pk_bf16_f32 v194, v72, v73
    v_cvt_pk_bf16_f32 v195, v74, v75
    v_mfma_f32_16x16x32_bf16 v[40:43], v[160:163], v[144:147], 0
    v_xor_b32 v250, 32, v252
    v_fma_f32 v14, v14, s26, v245
    ds_write_b64 v250, v[194:195] offset:0
    v_mul_f32 v76, v76, v249
    v_mul_f32 v77, v77, v249
    v_mul_f32 v78, v78, v249
    v_mfma_f32_16x16x32_bf16 v[32:35], v[164:167], v[132:135], v[32:35]
    ds_read_b128 v[180:183], v225 offset:36864
    s_add_u32 m0, s23, 32768
    s_add_u32 s27, s20, 49152
    buffer_load_dwordx4 v236, s[8:11], s27 offen nt lds
    v_mul_f32 v79, v79, v249
    v_exp_f32 v13, v13
    v_mfma_f32_16x16x32_bf16 v[40:43], v[164:167], v[148:151], v[40:43]
    v_cvt_pk_bf16_f32 v210, v76, v77
    v_cvt_pk_bf16_f32 v211, v78, v79
    v_mul_f32 v80, v80, v248
    v_mul_f32 v81, v81, v248
    s_waitcnt lgkmcnt(3)
    v_mfma_f32_16x16x32_bf16 v[32:35], v[168:171], v[136:139], v[32:35]
    ds_read_b128 v[184:187], v226 offset:36864
    v_mul_f32 v82, v82, v248
    v_add_f32 v247, v247, v11
    v_mfma_f32_16x16x32_bf16 v[40:43], v[168:171], v[152:155], v[40:43]
    v_mul_f32 v83, v83, v248
    v_cvt_pk_bf16_f32 v196, v80, v81
    v_cvt_pk_bf16_f32 v197, v82, v83
    v_xor_b32 v250, 64, v252
    ds_write_b64 v250, v[196:197] offset:0
    v_fma_f32 v15, v15, s26, v245
    v_mfma_f32_16x16x32_bf16 v[32:35], v[172:175], v[140:143], v[32:35]
    ds_read_b128 v[188:191], v227 offset:36864
    v_mul_f32 v84, v84, v249
    v_mul_f32 v85, v85, v249
    v_mfma_f32_16x16x32_bf16 v[40:43], v[172:175], v[156:159], v[40:43]
    v_mul_f32 v86, v86, v249
    v_mul_f32 v87, v87, v249
    v_cvt_pk_bf16_f32 v212, v84, v85
    v_exp_f32 v14, v14
    v_cvt_pk_bf16_f32 v213, v86, v87
    s_waitcnt lgkmcnt(3)
    v_mfma_f32_16x16x32_bf16 v[36:39], v[176:179], v[128:131], 0
    ds_read_b128 v[160:163], v224 offset:40960
    v_mul_f32 v88, v88, v248
    v_mul_f32 v89, v89, v248
    v_mfma_f32_16x16x32_bf16 v[44:47], v[176:179], v[144:147], 0
    v_mul_f32 v90, v90, v248
    v_mul_f32 v91, v91, v248
    v_add_f32 v247, v247, v12
    v_cvt_pk_bf16_f32 v198, v88, v89
    v_mfma_f32_16x16x32_bf16 v[36:39], v[180:183], v[132:135], v[36:39]
    ds_read_b128 v[164:167], v225 offset:40960
    buffer_load_dwordx4 v237, s[8:11], s27 offen offset:1024 nt lds
    v_cvt_pk_bf16_f32 v199, v90, v91
    v_xor_b32 v250, 96, v252
    v_mfma_f32_16x16x32_bf16 v[44:47], v[180:183], v[148:151], v[44:47]
    ds_write_b64 v250, v[198:199] offset:0
    v_mul_f32 v92, v92, v249
    v_cvt_pk_bf16_f32 v9, v10, v11
    v_mul_f32 v93, v93, v249
    v_mul_f32 v94, v94, v249
    v_mul_f32 v95, v95, v249
    s_waitcnt lgkmcnt(3)
    v_mfma_f32_16x16x32_bf16 v[36:39], v[184:187], v[136:139], v[36:39]
    ds_read_b128 v[168:171], v226 offset:40960
    v_cvt_pk_bf16_f32 v214, v92, v93
    v_cvt_pk_bf16_f32 v215, v94, v95
    v_mfma_f32_16x16x32_bf16 v[44:47], v[184:187], v[152:155], v[44:47]
    v_exp_f32 v15, v15
    v_mul_f32 v96, v96, v248
    v_mul_f32 v97, v97, v248
    v_mul_f32 v98, v98, v248
    v_mul_f32 v99, v99, v248
    v_mfma_f32_16x16x32_bf16 v[36:39], v[188:191], v[140:143], v[36:39]
    ds_read_b128 v[172:175], v227 offset:40960
    v_cvt_pk_bf16_f32 v200, v96, v97
    v_add_f32 v247, v247, v13
    v_mfma_f32_16x16x32_bf16 v[44:47], v[188:191], v[156:159], v[44:47]
    v_cvt_pk_bf16_f32 v201, v98, v99
    ds_write_b64 v252, v[200:201] offset:128
    v_mul_f32 v100, v100, v249
    v_mul_f32 v101, v101, v249
    v_mul_f32 v102, v102, v249
    v_add_f32 v247, v247, v14
    s_waitcnt lgkmcnt(4)
    v_mfma_f32_16x16x32_bf16 v[48:51], v[160:163], v[128:131], 0
    ds_read_b128 v[176:179], v224 offset:45056
    v_mul_f32 v103, v103, v249
    v_cvt_pk_bf16_f32 v216, v100, v101
    v_mfma_f32_16x16x32_bf16 v[56:59], v[160:163], v[144:147], 0
    v_cvt_pk_bf16_f32 v217, v102, v103
    v_mul_f32 v104, v104, v248
    v_mul_f32 v105, v105, v248
    v_cvt_pk_bf16_f32 v10, v12, v13
    v_mfma_f32_16x16x32_bf16 v[48:51], v[164:167], v[132:135], v[48:51]
    ds_read_b128 v[180:183], v225 offset:45056
    v_mul_f32 v106, v106, v248
    v_mul_f32 v107, v107, v248
    v_mfma_f32_16x16x32_bf16 v[56:59], v[164:167], v[148:151], v[56:59]
    v_cvt_pk_bf16_f32 v202, v104, v105
    v_cvt_pk_bf16_f32 v203, v106, v107
    v_xor_b32 v250, 32, v252
    v_add_f32 v247, v247, v15
    ds_write_b64 v250, v[202:203] offset:128
    v_mul_f32 v108, v108, v249
    s_waitcnt lgkmcnt(4)
    v_mfma_f32_16x16x32_bf16 v[48:51], v[168:171], v[136:139], v[48:51]
    ds_read_b128 v[184:187], v226 offset:45056
    v_mul_f32 v109, v109, v249
    v_mul_f32 v110, v110, v249
    v_mfma_f32_16x16x32_bf16 v[56:59], v[168:171], v[152:155], v[56:59]
    v_mul_f32 v111, v111, v249
    v_cvt_pk_bf16_f32 v11, v14, v15
    v_cvt_pk_bf16_f32 v218, v108, v109
    v_cvt_pk_bf16_f32 v219, v110, v111
    v_mul_f32 v112, v112, v248
    v_mfma_f32_16x16x32_bf16 v[48:51], v[172:175], v[140:143], v[48:51]
    ds_read_b128 v[188:191], v227 offset:45056
    v_mul_f32 v113, v113, v248
    v_mul_f32 v114, v114, v248
    v_mfma_f32_16x16x32_bf16 v[56:59], v[172:175], v[156:159], v[56:59]
    v_mul_f32 v115, v115, v248
    v_cvt_pk_bf16_f32 v204, v112, v113
    v_cvt_pk_bf16_f32 v205, v114, v115
    v_xor_b32 v250, 64, v252
    ds_write_b64 v250, v[204:205] offset:128
    s_waitcnt lgkmcnt(4)
    v_mfma_f32_16x16x32_bf16 v[52:55], v[176:179], v[128:131], 0
    s_waitcnt vmcnt(6) lgkmcnt(0)
    s_barrier
    ds_read_b64_tr_b16 v[160:161], v228 offset:49152
    ds_read_b64_tr_b16 v[162:163], v228 offset:53248
    v_mul_f32 v116, v116, v249
    v_mul_f32 v117, v117, v249
    v_mfma_f32_16x16x32_bf16 v[60:63], v[176:179], v[144:147], 0
    v_mul_f32 v118, v118, v249
    v_mul_f32 v119, v119, v249
    v_cvt_pk_bf16_f32 v220, v116, v117
    v_cvt_pk_bf16_f32 v221, v118, v119
    v_mul_f32 v120, v120, v248
    v_mfma_f32_16x16x32_bf16 v[52:55], v[180:183], v[132:135], v[52:55]
    ds_read_b64_tr_b16 v[164:165], v229 offset:49152
    ds_read_b64_tr_b16 v[166:167], v229 offset:53248
    v_mul_f32 v121, v121, v248
    v_mul_f32 v122, v122, v248
    v_mfma_f32_16x16x32_bf16 v[60:63], v[180:183], v[148:151], v[60:63]
    v_mul_f32 v123, v123, v248
    v_cvt_pk_bf16_f32 v206, v120, v121
    v_cvt_pk_bf16_f32 v207, v122, v123
    v_xor_b32 v250, 96, v252
    ds_write_b64 v250, v[206:207] offset:128
    v_mul_f32 v124, v124, v249
    v_mfma_f32_16x16x32_bf16 v[52:55], v[184:187], v[136:139], v[52:55]
    ds_read_b64_tr_b16 v[168:169], v230 offset:49152
    ds_read_b64_tr_b16 v[170:171], v230 offset:53248
    v_mul_f32 v125, v125, v249
    v_mul_f32 v126, v126, v249
    v_mfma_f32_16x16x32_bf16 v[60:63], v[184:187], v[152:155], v[60:63]
    v_mul_f32 v127, v127, v249
    v_cvt_pk_bf16_f32 v222, v124, v125
    v_cvt_pk_bf16_f32 v223, v126, v127
    ds_read_b128 v[192:195], v240 offset:0
    ds_read_b128 v[196:199], v240 offset:1024
    ds_read_b128 v[200:203], v240 offset:2048
    ds_read_b128 v[204:207], v240 offset:3072
    ds_write_b64 v252, v[208:209] offset:0
    v_xor_b32 v250, 32, v252
    ds_write_b64 v250, v[210:211] offset:0
    v_mfma_f32_16x16x32_bf16 v[52:55], v[188:191], v[140:143], v[52:55]
    ds_read_b64_tr_b16 v[172:173], v231 offset:49152
    ds_read_b64_tr_b16 v[174:175], v231 offset:53248
    v_xor_b32 v250, 64, v252
    s_waitcnt lgkmcnt(14)
    ds_write_b64 v250, v[212:213] offset:0
    v_mfma_f32_16x16x32_bf16 v[60:63], v[188:191], v[156:159], v[60:63]
    v_xor_b32 v250, 96, v252
    s_waitcnt lgkmcnt(14)
    ds_write_b64 v250, v[214:215] offset:0
    s_waitcnt lgkmcnt(14)
    ds_write_b64 v252, v[216:217] offset:128
    v_xor_b32 v250, 32, v252
    s_waitcnt lgkmcnt(14)
    ds_write_b64 v250, v[218:219] offset:128
    v_xor_b32 v250, 64, v252
    s_waitcnt lgkmcnt(14)
    ds_write_b64 v250, v[220:221] offset:128
    v_xor_b32 v250, 96, v252
    s_waitcnt lgkmcnt(14)
    ds_write_b64 v250, v[222:223] offset:128
    s_waitcnt lgkmcnt(14)
    ds_read_b128 v[208:211], v240 offset:0
    s_waitcnt lgkmcnt(14)
    ds_read_b128 v[212:215], v240 offset:1024
    s_waitcnt lgkmcnt(14)
    ds_read_b128 v[216:219], v240 offset:2048
    s_waitcnt lgkmcnt(14)
    ds_read_b128 v[220:223], v240 offset:3072
    v_fma_f32 v16, v16, s26, v244
    v_fma_f32 v17, v17, s26, v244
    v_mfma_f32_16x16x32_bf16 v[64:67], v[160:163], v[0:3], 0
    s_waitcnt lgkmcnt(14)
    ds_read_b64_tr_b16 v[176:177], v232 offset:49152
    s_waitcnt lgkmcnt(14)
    ds_read_b64_tr_b16 v[178:179], v232 offset:53248
    v_exp_f32 v16, v16
    v_fma_f32 v18, v18, s26, v244
    v_mfma_f32_16x16x32_bf16 v[68:71], v[160:163], v[8:11], 0
    v_exp_f32 v17, v17
    v_fma_f32 v19, v19, s26, v244
    v_exp_f32 v18, v18
    v_add_f32 v246, v246, v16
    v_fma_f32 v20, v20, s26, v244
    v_mfma_f32_16x16x32_bf16 v[72:75], v[164:167], v[0:3], 0
    s_waitcnt lgkmcnt(14)
    ds_read_b64_tr_b16 v[180:181], v233 offset:49152
    s_waitcnt lgkmcnt(14)
    ds_read_b64_tr_b16 v[182:183], v233 offset:53248
    s_add_u32 m0, s23, 49152
    s_add_u32 s27, s20, 32768
    buffer_load_dwordx4 v238, s[12:15], s27 offen nt lds
    v_exp_f32 v19, v19
    v_add_f32 v246, v246, v17
    v_mfma_f32_16x16x32_bf16 v[76:79], v[164:167], v[8:11], 0
    v_fma_f32 v21, v21, s26, v244
    v_exp_f32 v20, v20
    v_add_f32 v246, v246, v18
    v_cvt_pk_bf16_f32 v16, v16, v17
    v_fma_f32 v22, v22, s26, v244
    s_waitcnt lgkmcnt(14)
    v_mfma_f32_16x16x32_bf16 v[80:83], v[168:171], v[0:3], 0
    ds_read_b64_tr_b16 v[184:185], v234 offset:49152
    s_waitcnt lgkmcnt(14)
    ds_read_b64_tr_b16 v[186:187], v234 offset:53248
    v_exp_f32 v21, v21
    v_add_f32 v246, v246, v19
    v_mfma_f32_16x16x32_bf16 v[84:87], v[168:171], v[8:11], 0
    v_fma_f32 v23, v23, s26, v244
    v_exp_f32 v22, v22
    v_add_f32 v246, v246, v20
    v_cvt_pk_bf16_f32 v17, v18, v19
    v_mfma_f32_16x16x32_bf16 v[88:91], v[172:175], v[0:3], 0
    s_waitcnt lgkmcnt(14)
    ds_read_b64_tr_b16 v[188:189], v235 offset:49152
    s_waitcnt lgkmcnt(14)
    ds_read_b64_tr_b16 v[190:191], v235 offset:53248
    v_exp_f32 v23, v23
    v_add_f32 v246, v246, v21
    v_mfma_f32_16x16x32_bf16 v[92:95], v[172:175], v[8:11], 0
    v_add_f32 v246, v246, v22
    v_cvt_pk_bf16_f32 v18, v20, v21
    v_add_f32 v246, v246, v23
    v_cvt_pk_bf16_f32 v19, v22, v23
    v_fma_f32 v24, v24, s26, v245
    s_waitcnt lgkmcnt(4)
    v_mfma_f32_16x16x32_bf16 v[96:99], v[176:179], v[0:3], 0
    ds_read_b64_tr_b16 v[160:161], v228 offset:57344
    ds_read_b64_tr_b16 v[162:163], v228 offset:61440
    v_fma_f32 v25, v25, s26, v245
    v_exp_f32 v24, v24
    v_mfma_f32_16x16x32_bf16 v[100:103], v[176:179], v[8:11], 0
    v_fma_f32 v26, v26, s26, v245
    v_exp_f32 v25, v25
    v_fma_f32 v27, v27, s26, v245
    v_exp_f32 v26, v26
    v_add_f32 v247, v247, v24
    v_xor_b32 v224, 0x10000, v224
    v_mfma_f32_16x16x32_bf16 v[104:107], v[180:183], v[0:3], 0
    ds_read_b64_tr_b16 v[164:165], v229 offset:57344
    ds_read_b64_tr_b16 v[166:167], v229 offset:61440
    buffer_load_dwordx4 v239, s[12:15], s27 offen offset:1024 nt lds
    v_fma_f32 v28, v28, s26, v245
    v_exp_f32 v27, v27
    v_mfma_f32_16x16x32_bf16 v[108:111], v[180:183], v[8:11], 0
    v_add_f32 v247, v247, v25
    v_fma_f32 v29, v29, s26, v245
    v_exp_f32 v28, v28
    v_add_f32 v247, v247, v26
    v_xor_b32 v225, 0x10000, v225
    s_waitcnt lgkmcnt(4)
    v_mfma_f32_16x16x32_bf16 v[112:115], v[184:187], v[0:3], 0
    ds_read_b64_tr_b16 v[168:169], v230 offset:57344
    ds_read_b64_tr_b16 v[170:171], v230 offset:61440
    v_cvt_pk_bf16_f32 v24, v24, v25
    v_fma_f32 v30, v30, s26, v245
    v_mfma_f32_16x16x32_bf16 v[116:119], v[184:187], v[8:11], 0
    v_exp_f32 v29, v29
    v_add_f32 v247, v247, v27
    v_fma_f32 v31, v31, s26, v245
    v_exp_f32 v30, v30
    v_add_f32 v247, v247, v28
    v_xor_b32 v226, 0x10000, v226
    v_mfma_f32_16x16x32_bf16 v[120:123], v[188:191], v[0:3], 0
    ds_read_b64_tr_b16 v[172:173], v231 offset:57344
    ds_read_b64_tr_b16 v[174:175], v231 offset:61440
    v_cvt_pk_bf16_f32 v25, v26, v27
    v_exp_f32 v31, v31
    v_mfma_f32_16x16x32_bf16 v[124:127], v[188:191], v[8:11], 0
    v_add_f32 v247, v247, v29
    v_add_f32 v247, v247, v30
    v_cvt_pk_bf16_f32 v26, v28, v29
    v_add_f32 v247, v247, v31
    v_cvt_pk_bf16_f32 v27, v30, v31
    v_xor_b32 v227, 0x10000, v227
    s_waitcnt lgkmcnt(4)
    v_mfma_f32_16x16x32_bf16 v[64:67], v[160:163], v[16:19], v[64:67]
    ds_read_b64_tr_b16 v[176:177], v232 offset:57344
    ds_read_b64_tr_b16 v[178:179], v232 offset:61440
    v_max_f32 v242, v32, v33
    v_max_f32 v243, v40, v41
    v_mfma_f32_16x16x32_bf16 v[68:71], v[160:163], v[24:27], v[68:71]
    v_max3_f32 v242, v242, v34, v35
    v_max3_f32 v243, v243, v42, v43
    v_max3_f32 v242, v242, v36, v37
    v_max3_f32 v243, v243, v44, v45
    v_mfma_f32_16x16x32_bf16 v[72:75], v[164:167], v[16:19], v[72:75]
    ds_read_b64_tr_b16 v[180:181], v233 offset:57344
    ds_read_b64_tr_b16 v[182:183], v233 offset:61440
    v_max3_f32 v242, v242, v38, v39
    v_max3_f32 v243, v243, v46, v47
    v_mfma_f32_16x16x32_bf16 v[76:79], v[164:167], v[24:27], v[76:79]
    v_max3_f32 v242, v242, v48, v49
    v_max3_f32 v243, v243, v56, v57
    v_max3_f32 v242, v242, v50, v51
    s_waitcnt lgkmcnt(4)
    v_mfma_f32_16x16x32_bf16 v[80:83], v[168:171], v[16:19], v[80:83]
    ds_read_b64_tr_b16 v[184:185], v234 offset:57344
    ds_read_b64_tr_b16 v[186:187], v234 offset:61440
    v_max3_f32 v243, v243, v58, v59
    v_max3_f32 v242, v242, v52, v53
    v_mfma_f32_16x16x32_bf16 v[84:87], v[168:171], v[24:27], v[84:87]
    v_max3_f32 v243, v243, v60, v61
    v_max3_f32 v242, v242, v54, v55
    v_mfma_f32_16x16x32_bf16 v[88:91], v[172:175], v[16:19], v[88:91]
    ds_read_b64_tr_b16 v[188:189], v235 offset:57344
    ds_read_b64_tr_b16 v[190:191], v235 offset:61440
    v_max3_f32 v243, v243, v62, v63
    v_fma_f32 v250, v242, s26, v244
    v_mfma_f32_16x16x32_bf16 v[92:95], v[172:175], v[24:27], v[92:95]
    v_fma_f32 v251, v243, s26, v245
    v_max_f32 v250, v250, v251
    v_cmp_lt_f32 vcc, s35, v250
    s_cbranch_vccnz L_rareL1
L_backL1:
    s_waitcnt lgkmcnt(4)
    v_mfma_f32_16x16x32_bf16 v[96:99], v[176:179], v[16:19], v[96:99]
    s_waitcnt vmcnt(6) lgkmcnt(0)
    s_barrier
    ds_read_b128 v[160:163], v224 offset:0
    v_fma_f32 v32, v32, s26, v244
    v_fma_f32 v33, v33, s26, v244
    v_mfma_f32_16x16x32_bf16 v[100:103], v[176:179], v[24:27], v[100:103]
    v_exp_f32 v32, v32
    v_fma_f32 v34, v34, s26, v244
    v_mfma_f32_16x16x32_bf16 v[104:107], v[180:183], v[16:19], v[104:107]
    ds_read_b128 v[164:167], v225 offset:0
    v_exp_f32 v33, v33
    v_fma_f32 v35, v35, s26, v244
    v_mfma_f32_16x16x32_bf16 v[108:111], v[180:183], v[24:27], v[108:111]
    v_exp_f32 v34, v34
    v_add_f32 v246, v246, v32
    v_mfma_f32_16x16x32_bf16 v[112:115], v[184:187], v[16:19], v[112:115]
    ds_read_b128 v[168:171], v226 offset:0
    v_fma_f32 v36, v36, s26, v244
    v_exp_f32 v35, v35
    v_mfma_f32_16x16x32_bf16 v[116:119], v[184:187], v[24:27], v[116:119]
    v_add_f32 v246, v246, v33
    v_fma_f32 v37, v37, s26, v244
    v_exp_f32 v36, v36
    v_mfma_f32_16x16x32_bf16 v[120:123], v[188:191], v[16:19], v[120:123]
    ds_read_b128 v[172:175], v227 offset:0
    v_add_f32 v246, v246, v34
    v_cvt_pk_bf16_f32 v32, v32, v33
    v_mfma_f32_16x16x32_bf16 v[124:127], v[188:191], v[24:27], v[124:127]
    v_fma_f32 v38, v38, s26, v244
    v_exp_f32 v37, v37
    s_waitcnt lgkmcnt(2)
    v_mfma_f32_16x16x32_bf16 v[0:3], v[160:163], v[128:131], 0
    ds_read_b128 v[176:179], v224 offset:4096
    v_add_f32 v246, v246, v35
    v_fma_f32 v39, v39, s26, v244
    v_mfma_f32_16x16x32_bf16 v[8:11], v[160:163], v[144:147], 0
    v_exp_f32 v38, v38
    v_add_f32 v246, v246, v36
    v_cvt_pk_bf16_f32 v33, v34, v35
    v_mfma_f32_16x16x32_bf16 v[0:3], v[164:167], v[132:135], v[0:3]
    ds_read_b128 v[180:183], v225 offset:4096
    buffer_store_dwordx4 v[192:195], v241, s[16:19], s33 offen sc1
    v_exp_f32 v39, v39
    v_add_f32 v246, v246, v37
    v_mfma_f32_16x16x32_bf16 v[8:11], v[164:167], v[148:151], v[8:11]
    v_add_f32 v246, v246, v38
    v_cvt_pk_bf16_f32 v34, v36, v37
    s_waitcnt lgkmcnt(2)
    v_mfma_f32_16x16x32_bf16 v[0:3], v[168:171], v[136:139], v[0:3]
    ds_read_b128 v[184:187], v226 offset:4096
    v_add_f32 v246, v246, v39
    v_cvt_pk_bf16_f32 v35, v38, v39
    v_mfma_f32_16x16x32_bf16 v[8:11], v[168:171], v[152:155], v[8:11]
    v_fma_f32 v40, v40, s26, v245
    v_fma_f32 v41, v41, s26, v245
    v_xor_b32 v228, 0x10000, v228
    v_mfma_f32_16x16x32_bf16 v[0:3], v[172:175], v[140:143], v[0:3]
    ds_read_b128 v[188:191], v227 offset:4096
    v_exp_f32 v40, v40
    v_fma_f32 v42, v42, s26, v245
    v_mfma_f32_16x16x32_bf16 v[8:11], v[172:175], v[156:159], v[8:11]
    v_exp_f32 v41, v41
    v_fma_f32 v43, v43, s26, v245
    v_exp_f32 v42, v42
    v_xor_b32 v229, 0x10000, v229
    s_waitcnt lgkmcnt(2)
    v_mfma_f32_16x16x32_bf16 v[4:7], v[176:179], v[128:131], 0
    ds_read_b128 v[160:163], v224 offset:8192
    v_add_f32 v247, v247, v40
    v_fma_f32 v44, v44, s26, v245
    v_mfma_f32_16x16x32_bf16 v[12:15], v[176:179], v[144:147], 0
    v_exp_f32 v43, v43
    v_add_f32 v247, v247, v41
    v_xor_b32 v230, 0x10000, v230
    v_mfma_f32_16x16x32_bf16 v[4:7], v[180:183], v[132:135], v[4:7]
    ds_read_b128 v[164:167], v225 offset:8192
    buffer_store_dwordx4 v[196:199], v253, s[16:19], s33 offen offset:1024 sc1
    v_fma_f32 v45, v45, s26, v245
    v_exp_f32 v44, v44
    v_mfma_f32_16x16x32_bf16 v[12:15], v[180:183], v[148:151], v[12:15]
    v_add_f32 v247, v247, v42
    v_cvt_pk_bf16_f32 v40, v40, v41
    v_fma_f32 v46, v46, s26, v245
    v_xor_b32 v231, 0x10000, v231
    s_waitcnt lgkmcnt(2)
    v_mfma_f32_16x16x32_bf16 v[4:7], v[184:187], v[136:139], v[4:7]
    ds_read_b128 v[168:171], v226 offset:8192
    v_exp_f32 v45, v45
    v_add_f32 v247, v247, v43
    v_mfma_f32_16x16x32_bf16 v[12:15], v[184:187], v[152:155], v[12:15]
    v_fma_f32 v47, v47, s26, v245
    v_exp_f32 v46, v46
    v_xor_b32 v232, 0x10000, v232
    v_mfma_f32_16x16x32_bf16 v[4:7], v[188:191], v[140:143], v[4:7]
    ds_read_b128 v[172:175], v227 offset:8192
    v_add_f32 v247, v247, v44
    v_cvt_pk_bf16_f32 v41, v42, v43
    v_mfma_f32_16x16x32_bf16 v[12:15], v[188:191], v[156:159], v[12:15]
    v_exp_f32 v47, v47
    v_add_f32 v247, v247, v45
    v_xor_b32 v233, 0x10000, v233
    s_waitcnt lgkmcnt(2)
    v_mfma_f32_16x16x32_bf16 v[16:19], v[160:163], v[128:131], 0
    ds_read_b128 v[176:179], v224 offset:12288
    v_add_f32 v247, v247, v46
    v_cvt_pk_bf16_f32 v42, v44, v45
    v_mfma_f32_16x16x32_bf16 v[24:27], v[160:163], v[144:147], 0
    v_add_f32 v247, v247, v47
    v_cvt_pk_bf16_f32 v43, v46, v47
    v_fma_f32 v48, v48, s26, v244
    v_xor_b32 v234, 0x10000, v234
    v_mfma_f32_16x16x32_bf16 v[16:19], v[164:167], v[132:135], v[16:19]
    ds_read_b128 v[180:183], v225 offset:12288
    v_fma_f32 v49, v49, s26, v244
    v_exp_f32 v48, v48
    v_mfma_f32_16x16x32_bf16 v[24:27], v[164:167], v[148:151], v[24:27]
    v_fma_f32 v50, v50, s26, v244
    v_exp_f32 v49, v49
    v_xor_b32 v235, 0x10000, v235
    s_waitcnt lgkmcnt(2)
    v_mfma_f32_16x16x32_bf16 v[16:19], v[168:171], v[136:139], v[16:19]
    ds_read_b128 v[184:187], v226 offset:12288
    v_fma_f32 v51, v51, s26, v244
    v_exp_f32 v50, v50
    v_mfma_f32_16x16x32_bf16 v[24:27], v[168:171], v[152:155], v[24:27]
    v_add_f32 v246, v246, v48
    v_fma_f32 v52, v52, s26, v244
    v_exp_f32 v51, v51
    v_mfma_f32_16x16x32_bf16 v[16:19], v[172:175], v[140:143], v[16:19]
    ds_read_b128 v[188:191], v227 offset:12288
    v_add_f32 v246, v246, v49
    v_fma_f32 v53, v53, s26, v244
    v_mfma_f32_16x16x32_bf16 v[24:27], v[172:175], v[156:159], v[24:27]
    v_exp_f32 v52, v52
    v_add_f32 v246, v246, v50
    s_waitcnt lgkmcnt(2)
    v_mfma_f32_16x16x32_bf16 v[20:23], v[176:179], v[128:131], 0
    s_waitcnt vmcnt(6) lgkmcnt(0)
    s_barrier
    ds_read_b64_tr_b16 v[160:161], v228 offset:16384
    ds_read_b64_tr_b16 v[162:163], v228 offset:20480
    v_cvt_pk_bf16_f32 v48, v48, v49
    v_fma_f32 v54, v54, s26, v244
    v_mfma_f32_16x16x32_bf16 v[28:31], v[176:179], v[144:147], 0
    v_exp_f32 v53, v53
    v_add_f32 v246, v246, v51
    v_mfma_f32_16x16x32_bf16 v[20:23], v[180:183], v[132:135], v[20:23]
    ds_read_b64_tr_b16 v[164:165], v229 offset:16384
    ds_read_b64_tr_b16 v[166:167], v229 offset:20480
    v_fma_f32 v55, v55, s26, v244
    v_exp_f32 v54, v54
    v_mfma_f32_16x16x32_bf16 v[28:31], v[180:183], v[148:151], v[28:31]
    v_add_f32 v246, v246, v52
    v_cvt_pk_bf16_f32 v49, v50, v51
    v_exp_f32 v55, v55
    v_mfma_f32_16x16x32_bf16 v[20:23], v[184:187], v[136:139], v[20:23]
    ds_read_b64_tr_b16 v[168:169], v230 offset:16384
    ds_read_b64_tr_b16 v[170:171], v230 offset:20480
    v_add_f32 v246, v246, v53
    v_add_f32 v246, v246, v54
    v_mfma_f32_16x16x32_bf16 v[28:31], v[184:187], v[152:155], v[28:31]
    v_cvt_pk_bf16_f32 v50, v52, v53
    v_add_f32 v246, v246, v55
    v_mfma_f32_16x16x32_bf16 v[20:23], v[188:191], v[140:143], v[20:23]
    ds_read_b64_tr_b16 v[172:173], v231 offset:16384
    ds_read_b64_tr_b16 v[174:175], v231 offset:20480
    v_cvt_pk_bf16_f32 v51, v54, v55
    v_max_f32 v242, v0, v1
    v_mfma_f32_16x16x32_bf16 v[28:31], v[188:191], v[156:159], v[28:31]
    v_max_f32 v243, v8, v9
    v_max3_f32 v242, v242, v2, v3
    v_max3_f32 v243, v243, v10, v11
    s_waitcnt lgkmcnt(4)
    v_mfma_f32_16x16x32_bf16 v[64:67], v[160:163], v[32:35], v[64:67]
    ds_read_b64_tr_b16 v[176:177], v232 offset:16384
    ds_read_b64_tr_b16 v[178:179], v232 offset:20480
    v_max3_f32 v242, v242, v4, v5
    v_max3_f32 v243, v243, v12, v13
    v_mfma_f32_16x16x32_bf16 v[68:71], v[160:163], v[40:43], v[68:71]
    v_max3_f32 v242, v242, v6, v7
    v_max3_f32 v243, v243, v14, v15
    v_mfma_f32_16x16x32_bf16 v[72:75], v[164:167], v[32:35], v[72:75]
    ds_read_b64_tr_b16 v[180:181], v233 offset:16384
    ds_read_b64_tr_b16 v[182:183], v233 offset:20480
    buffer_store_dwordx4 v[200:203], v241, s[16:19], s33 offen offset:2048 sc1
    v_fma_f32 v56, v56, s26, v245
    v_fma_f32 v57, v57, s26, v245
    v_mfma_f32_16x16x32_bf16 v[76:79], v[164:167], v[40:43], v[76:79]
    v_exp_f32 v56, v56
    v_fma_f32 v58, v58, s26, v245
    s_waitcnt lgkmcnt(4)
    v_mfma_f32_16x16x32_bf16 v[80:83], v[168:171], v[32:35], v[80:83]
    ds_read_b64_tr_b16 v[184:185], v234 offset:16384
    ds_read_b64_tr_b16 v[186:187], v234 offset:20480
    v_exp_f32 v57, v57
    v_fma_f32 v59, v59, s26, v245
    v_mfma_f32_16x16x32_bf16 v[84:87], v[168:171], v[40:43], v[84:87]
    v_exp_f32 v58, v58
    v_add_f32 v247, v247, v56
    v_fma_f32 v60, v60, s26, v245
    v_mfma_f32_16x16x32_bf16 v[88:91], v[172:175], v[32:35], v[88:91]
    ds_read_b64_tr_b16 v[188:189], v235 offset:16384
    ds_read_b64_tr_b16 v[190:191], v235 offset:20480
    v_exp_f32 v59, v59
    v_add_f32 v247, v247, v57
    v_mfma_f32_16x16x32_bf16 v[92:95], v[172:175], v[40:43], v[92:95]
    v_fma_f32 v61, v61, s26, v245
    v_exp_f32 v60, v60
    s_waitcnt lgkmcnt(4)
    v_mfma_f32_16x16x32_bf16 v[96:99], v[176:179], v[32:35], v[96:99]
    ds_read_b64_tr_b16 v[160:161], v228 offset:24576
    ds_read_b64_tr_b16 v[162:163], v228 offset:28672
    v_add_f32 v247, v247, v58
    v_cvt_pk_bf16_f32 v56, v56, v57
    v_mfma_f32_16x16x32_bf16 v[100:103], v[176:179], v[40:43], v[100:103]
    v_fma_f32 v62, v62, s26, v245
    v_exp_f32 v61, v61
    v_add_f32 v247, v247, v59
    v_mfma_f32_16x16x32_bf16 v[104:107], v[180:183], v[32:35], v[104:107]
    ds_read_b64_tr_b16 v[164:165], v229 offset:24576
    ds_read_b64_tr_b16 v[166:167], v229 offset:28672
    buffer_store_dwordx4 v[204:207], v253, s[16:19], s33 offen offset:3072 sc1
    v_fma_f32 v63, v63, s26, v245
    v_exp_f32 v62, v62
    v_mfma_f32_16x16x32_bf16 v[108:111], v[180:183], v[40:43], v[108:111]
    v_add_f32 v247, v247, v60
    v_cvt_pk_bf16_f32 v57, v58, v59
    s_waitcnt lgkmcnt(4)
    v_mfma_f32_16x16x32_bf16 v[112:115], v[184:187], v[32:35], v[112:115]
    ds_read_b64_tr_b16 v[168:169], v230 offset:24576
    ds_read_b64_tr_b16 v[170:171], v230 offset:28672
    v_exp_f32 v63, v63
    v_add_f32 v247, v247, v61
    v_mfma_f32_16x16x32_bf16 v[116:119], v[184:187], v[40:43], v[116:119]
    v_add_f32 v247, v247, v62
    v_cvt_pk_bf16_f32 v58, v60, v61
    v_mfma_f32_16x16x32_bf16 v[120:123], v[188:191], v[32:35], v[120:123]
    ds_read_b64_tr_b16 v[172:173], v231 offset:24576
    ds_read_b64_tr_b16 v[174:175], v231 offset:28672
    v_add_f32 v247, v247, v63
    v_cvt_pk_bf16_f32 v59, v62, v63
    v_mfma_f32_16x16x32_bf16 v[124:127], v[188:191], v[40:43], v[124:127]
    v_max3_f32 v242, v242, v16, v17
    v_max3_f32 v243, v243, v24, v25
    v_max3_f32 v242, v242, v18, v19
    s_waitcnt lgkmcnt(4)
    v_mfma_f32_16x16x32_bf16 v[64:67], v[160:163], v[48:51], v[64:67]
    ds_read_b64_tr_b16 v[176:177], v232 offset:24576
    ds_read_b64_tr_b16 v[178:179], v232 offset:28672
    v_max3_f32 v243, v243, v26, v27
    v_max3_f32 v242, v242, v20, v21
    v_mfma_f32_16x16x32_bf16 v[68:71], v[160:163], v[56:59], v[68:71]
    v_max3_f32 v243, v243, v28, v29
    v_max3_f32 v242, v242, v22, v23
    v_mfma_f32_16x16x32_bf16 v[72:75], v[164:167], v[48:51], v[72:75]
    ds_read_b64_tr_b16 v[180:181], v233 offset:24576
    ds_read_b64_tr_b16 v[182:183], v233 offset:28672
    v_max3_f32 v243, v243, v30, v31
    v_fma_f32 v250, v242, s26, v244
    v_mfma_f32_16x16x32_bf16 v[76:79], v[164:167], v[56:59], v[76:79]
    v_fma_f32 v251, v243, s26, v245
    v_max_f32 v250, v250, v251
    v_cmp_lt_f32 vcc, s35, v250
    s_cbranch_vccnz L_rareL2
L_backL2:
    s_waitcnt lgkmcnt(4)
    v_mfma_f32_16x16x32_bf16 v[80:83], v[168:171], v[48:51], v[80:83]
    ds_read_b64_tr_b16 v[184:185], v234 offset:24576
    ds_read_b64_tr_b16 v[186:187], v234 offset:28672
    v_fma_f32 v0, v0, s26, v244
    v_fma_f32 v1, v1, s26, v244
    v_mfma_f32_16x16x32_bf16 v[84:87], v[168:171], v[56:59], v[84:87]
    v_exp_f32 v0, v0
    v_fma_f32 v2, v2, s26, v244
    v_mfma_f32_16x16x32_bf16 v[88:91], v[172:175], v[48:51], v[88:91]
    ds_read_b64_tr_b16 v[188:189], v235 offset:24576
    ds_read_b64_tr_b16 v[190:191], v235 offset:28672
    v_exp_f32 v1, v1
    v_fma_f32 v3, v3, s26, v244
    v_mfma_f32_16x16x32_bf16 v[92:95], v[172:175], v[56:59], v[92:95]
    v_exp_f32 v2, v2
    v_add_f32 v246, v246, v0
    s_waitcnt lgkmcnt(4)
    v_mfma_f32_16x16x32_bf16 v[96:99], v[176:179], v[48:51], v[96:99]
    s_waitcnt vmcnt(6) lgkmcnt(0)
    s_barrier
    ds_read_b128 v[160:163], v224 offset:32768
    v_fma_f32 v4, v4, s26, v244
    v_exp_f32 v3, v3
    v_mfma_f32_16x16x32_bf16 v[100:103], v[176:179], v[56:59], v[100:103]
    v_add_f32 v246, v246, v1
    v_fma_f32 v5, v5, s26, v244
    v_exp_f32 v4, v4
    v_mfma_f32_16x16x32_bf16 v[104:107], v[180:183], v[48:51], v[104:107]
    ds_read_b128 v[164:167], v225 offset:32768
    v_add_f32 v246, v246, v2
    v_cvt_pk_bf16_f32 v0, v0, v1
    v_mfma_f32_16x16x32_bf16 v[108:111], v[180:183], v[56:59], v[108:111]
    v_fma_f32 v6, v6, s26, v244
    v_exp_f32 v5, v5
    v_mfma_f32_16x16x32_bf16 v[112:115], v[184:187], v[48:51], v[112:115]
    ds_read_b128 v[168:171], v226 offset:32768
    v_add_f32 v246, v246, v3
    v_fma_f32 v7, v7, s26, v244
    v_mfma_f32_16x16x32_bf16 v[116:119], v[184:187], v[56:59], v[116:119]
    v_exp_f32 v6, v6
    v_add_f32 v246, v246, v4
    v_cvt_pk_bf16_f32 v1, v2, v3
    v_mfma_f32_16x16x32_bf16 v[120:123], v[188:191], v[48:51], v[120:123]
    ds_read_b128 v[172:175], v227 offset:32768
    v_exp_f32 v7, v7
    v_add_f32 v246, v246, v5
    v_mfma_f32_16x16x32_bf16 v[124:127], v[188:191], v[56:59], v[124:127]
    v_add_f32 v246, v246, v6
    v_cvt_pk_bf16_f32 v2, v4, v5
    s_waitcnt lgkmcnt(2)
    v_mfma_f32_16x16x32_bf16 v[32:35], v[160:163], v[128:131], 0
    ds_read_b128 v[176:179], v224 offset:36864
    v_add_f32 v246, v246, v7
    v_cvt_pk_bf16_f32 v3, v6, v7
    v_mfma_f32_16x16x32_bf16 v[40:43], v[160:163], v[144:147], 0
    v_fma_f32 v8, v8, s26, v245
    v_fma_f32 v9, v9, s26, v245
    v_mfma_f32_16x16x32_bf16 v[32:35], v[164:167], v[132:135], v[32:35]
    ds_read_b128 v[180:183], v225 offset:36864
    s_add_u32 m0, s23, 16384
    s_add_u32 s27, s20, 49152
    buffer_load_dwordx4 v238, s[12:15], s27 offen nt lds
    v_exp_f32 v8, v8
    v_fma_f32 v10, v10, s26, v245
    v_mfma_f32_16x16x32_bf16 v[40:43], v[164:167], v[148:151], v[40:43]
    v_exp_f32 v9, v9
    v_fma_f32 v11, v11, s26, v245
    v_exp_f32 v10, v10
    s_waitcnt lgkmcnt(2)
    v_mfma_f32_16x16x32_bf16 v[32:35], v[168:171], v[136:139], v[32:35]
    ds_read_b128 v[184:187], v226 offset:36864
    v_add_f32 v247, v247, v8
    v_fma_f32 v12, v12, s26, v245
    v_mfma_f32_16x16x32_bf16 v[40:43], v[168:171], v[152:155], v[40:43]
    v_exp_f32 v11, v11
    v_add_f32 v247, v247, v9
    v_mfma_f32_16x16x32_bf16 v[32:35], v[172:175], v[140:143], v[32:35]
    ds_read_b128 v[188:191], v227 offset:36864
    v_fma_f32 v13, v13, s26, v245
    v_exp_f32 v12, v12
    v_mfma_f32_16x16x32_bf16 v[40:43], v[172:175], v[156:159], v[40:43]
    v_add_f32 v247, v247, v10
    v_cvt_pk_bf16_f32 v8, v8, v9
    v_fma_f32 v14, v14, s26, v245
    s_waitcnt lgkmcnt(2)
    v_mfma_f32_16x16x32_bf16 v[36:39], v[176:179], v[128:131], 0
    ds_read_b128 v[160:163], v224 offset:40960
    v_exp_f32 v13, v13
    v_add_f32 v247, v247, v11
    v_mfma_f32_16x16x32_bf16 v[44:47], v[176:179], v[144:147], 0
    v_fma_f32 v15, v15, s26, v245
    v_exp_f32 v14, v14
    v_mfma_f32_16x16x32_bf16 v[36:39], v[180:183], v[132:135], v[36:39]
    ds_read_b128 v[164:167], v225 offset:40960
    buffer_load_dwordx4 v239, s[12:15], s27 offen offset:1024 nt lds
    v_add_f32 v247, v247, v12
    v_cvt_pk_bf16_f32 v9, v10, v11
    v_mfma_f32_16x16x32_bf16 v[44:47], v[180:183], v[148:151], v[44:47]
    v_exp_f32 v15, v15
    v_add_f32 v247, v247, v13
    s_waitcnt lgkmcnt(2)
    v_mfma_f32_16x16x32_bf16 v[36:39], v[184:187], v[136:139], v[36:39]
    ds_read_b128 v[168:171], v226 offset:40960
    v_add_f32 v247, v247, v14
    v_cvt_pk_bf16_f32 v10, v12, v13
    v_mfma_f32_16x16x32_bf16 v[44:47], v[184:187], v[152:155], v[44:47]
    v_add_f32 v247, v247, v15
    v_cvt_pk_bf16_f32 v11, v14, v15
    v_fma_f32 v16, v16, s26, v244
    v_mfma_f32_16x16x32_bf16 v[36:39], v[188:191], v[140:143], v[36:39]
    ds_read_b128 v[172:175], v227 offset:40960
    v_fma_f32 v17, v17, s26, v244
    v_exp_f32 v16, v16
    v_mfma_f32_16x16x32_bf16 v[44:47], v[188:191], v[156:159], v[44:47]
    v_fma_f32 v18, v18, s26, v244
    v_exp_f32 v17, v17
    s_waitcnt lgkmcnt(2)
    v_mfma_f32_16x16x32_bf16 v[48:51], v[160:163], v[128:131], 0
    ds_read_b128 v[176:179], v224 offset:45056
    v_fma_f32 v19, v19, s26, v244
    v_exp_f32 v18, v18
    v_mfma_f32_16x16x32_bf16 v[56:59], v[160:163], v[144:147], 0
    v_add_f32 v246, v246, v16
    v_fma_f32 v20, v20, s26, v244
    v_exp_f32 v19, v19
    v_mfma_f32_16x16x32_bf16 v[48:51], v[164:167], v[132:135], v[48:51]
    ds_read_b128 v[180:183], v225 offset:45056
    buffer_store_dwordx4 v[208:211], v241, s[16:19], s34 offen sc1
    v_add_f32 v246, v246, v17
    v_fma_f32 v21, v21, s26, v244
    v_mfma_f32_16x16x32_bf16 v[56:59], v[164:167], v[148:151], v[56:59]
    v_exp_f32 v20, v20
    v_add_f32 v246, v246, v18
    s_waitcnt lgkmcnt(2)
    v_mfma_f32_16x16x32_bf16 v[48:51], v[168:171], v[136:139], v[48:51]
    ds_read_b128 v[184:187], v226 offset:45056
    v_cvt_pk_bf16_f32 v16, v16, v17
    v_fma_f32 v22, v22, s26, v244
    v_mfma_f32_16x16x32_bf16 v[56:59], v[168:171], v[152:155], v[56:59]
    v_exp_f32 v21, v21
    v_add_f32 v246, v246, v19
    v_mfma_f32_16x16x32_bf16 v[48:51], v[172:175], v[140:143], v[48:51]
    ds_read_b128 v[188:191], v227 offset:45056
    v_fma_f32 v23, v23, s26, v244
    v_exp_f32 v22, v22
    v_mfma_f32_16x16x32_bf16 v[56:59], v[172:175], v[156:159], v[56:59]
    v_add_f32 v246, v246, v20
    v_cvt_pk_bf16_f32 v17, v18, v19
    v_exp_f32 v23, v23
    s_waitcnt lgkmcnt(2)
    v_mfma_f32_16x16x32_bf16 v[52:55], v[176:179], v[128:131], 0
    s_waitcnt vmcnt(7) lgkmcnt(0)
    s_barrier
    ds_read_b64_tr_b16 v[160:161], v228 offset:49152
    ds_read_b64_tr_b16 v[162:163], v228 offset:53248
    v_add_f32 v246, v246, v21
    v_add_f32 v246, v246, v22
    v_mfma_f32_16x16x32_bf16 v[60:63], v[176:179], v[144:147], 0
    v_cvt_pk_bf16_f32 v18, v20, v21
    v_add_f32 v246, v246, v23
    v_mfma_f32_16x16x32_bf16 v[52:55], v[180:183], v[132:135], v[52:55]
    ds_read_b64_tr_b16 v[164:165], v229 offset:49152
    ds_read_b64_tr_b16 v[166:167], v229 offset:53248
    buffer_store_dwordx4 v[212:215], v253, s[16:19], s34 offen offset:1024 sc1
    v_cvt_pk_bf16_f32 v19, v22, v23
    v_max_f32 v242, v32, v33
    v_mfma_f32_16x16x32_bf16 v[60:63], v[180:183], v[148:151], v[60:63]
    v_max_f32 v243, v40, v41
    v_max3_f32 v242, v242, v34, v35
    v_max3_f32 v243, v243, v42, v43
    v_mfma_f32_16x16x32_bf16 v[52:55], v[184:187], v[136:139], v[52:55]
    ds_read_b64_tr_b16 v[168:169], v230 offset:49152
    ds_read_b64_tr_b16 v[170:171], v230 offset:53248
    v_max3_f32 v242, v242, v36, v37
    v_max3_f32 v243, v243, v44, v45
    v_mfma_f32_16x16x32_bf16 v[60:63], v[184:187], v[152:155], v[60:63]
    v_max3_f32 v242, v242, v38, v39
    v_max3_f32 v243, v243, v46, v47
    v_mfma_f32_16x16x32_bf16 v[52:55], v[188:191], v[140:143], v[52:55]
    ds_read_b64_tr_b16 v[172:173], v231 offset:49152
    ds_read_b64_tr_b16 v[174:175], v231 offset:53248
    v_fma_f32 v24, v24, s26, v245
    v_fma_f32 v25, v25, s26, v245
    v_mfma_f32_16x16x32_bf16 v[60:63], v[188:191], v[156:159], v[60:63]
    v_exp_f32 v24, v24
    v_fma_f32 v26, v26, s26, v245
    s_waitcnt lgkmcnt(4)
    v_mfma_f32_16x16x32_bf16 v[64:67], v[160:163], v[0:3], v[64:67]
    ds_read_b64_tr_b16 v[176:177], v232 offset:49152
    ds_read_b64_tr_b16 v[178:179], v232 offset:53248
    v_exp_f32 v25, v25
    v_fma_f32 v27, v27, s26, v245
    v_mfma_f32_16x16x32_bf16 v[68:71], v[160:163], v[8:11], v[68:71]
    v_exp_f32 v26, v26
    v_add_f32 v247, v247, v24
    v_fma_f32 v28, v28, s26, v245
    v_mfma_f32_16x16x32_bf16 v[72:75], v[164:167], v[0:3], v[72:75]
    ds_read_b64_tr_b16 v[180:181], v233 offset:49152
    ds_read_b64_tr_b16 v[182:183], v233 offset:53248
    buffer_store_dwordx4 v[216:219], v241, s[16:19], s34 offen offset:2048 sc1
    v_exp_f32 v27, v27
    v_add_f32 v247, v247, v25
    v_mfma_f32_16x16x32_bf16 v[76:79], v[164:167], v[8:11], v[76:79]
    v_fma_f32 v29, v29, s26, v245
    v_exp_f32 v28, v28
    s_waitcnt lgkmcnt(4)
    v_mfma_f32_16x16x32_bf16 v[80:83], v[168:171], v[0:3], v[80:83]
    ds_read_b64_tr_b16 v[184:185], v234 offset:49152
    ds_read_b64_tr_b16 v[186:187], v234 offset:53248
    v_add_f32 v247, v247, v26
    v_cvt_pk_bf16_f32 v24, v24, v25
    v_mfma_f32_16x16x32_bf16 v[84:87], v[168:171], v[8:11], v[84:87]
    v_fma_f32 v30, v30, s26, v245
    v_exp_f32 v29, v29
    v_add_f32 v247, v247, v27
    v_mfma_f32_16x16x32_bf16 v[88:91], v[172:175], v[0:3], v[88:91]
    ds_read_b64_tr_b16 v[188:189], v235 offset:49152
    ds_read_b64_tr_b16 v[190:191], v235 offset:53248
    v_fma_f32 v31, v31, s26, v245
    v_exp_f32 v30, v30
    v_mfma_f32_16x16x32_bf16 v[92:95], v[172:175], v[8:11], v[92:95]
    v_add_f32 v247, v247, v28
    v_cvt_pk_bf16_f32 v25, v26, v27
    s_waitcnt lgkmcnt(4)
    v_mfma_f32_16x16x32_bf16 v[96:99], v[176:179], v[0:3], v[96:99]
    ds_read_b64_tr_b16 v[160:161], v228 offset:57344
    ds_read_b64_tr_b16 v[162:163], v228 offset:61440
    v_exp_f32 v31, v31
    v_add_f32 v247, v247, v29
    v_mfma_f32_16x16x32_bf16 v[100:103], v[176:179], v[8:11], v[100:103]
    v_add_f32 v247, v247, v30
    v_cvt_pk_bf16_f32 v26, v28, v29
    v_mfma_f32_16x16x32_bf16 v[104:107], v[180:183], v[0:3], v[104:107]
    ds_read_b64_tr_b16 v[164:165], v229 offset:57344
    ds_read_b64_tr_b16 v[166:167], v229 offset:61440
    buffer_store_dwordx4 v[220:223], v253, s[16:19], s34 offen offset:3072 sc1
    v_add_f32 v247, v247, v31
    v_cvt_pk_bf16_f32 v27, v30, v31
    v_mfma_f32_16x16x32_bf16 v[108:111], v[180:183], v[8:11], v[108:111]
    v_max3_f32 v242, v242, v48, v49
    v_max3_f32 v243, v243, v56, v57
    v_max3_f32 v242, v242, v50, v51
    s_waitcnt lgkmcnt(4)
    v_mfma_f32_16x16x32_bf16 v[112:115], v[184:187], v[0:3], v[112:115]
    ds_read_b64_tr_b16 v[168:169], v230 offset:57344
    ds_read_b64_tr_b16 v[170:171], v230 offset:61440
    v_max3_f32 v243, v243, v58, v59
    v_max3_f32 v242, v242, v52, v53
    v_mfma_f32_16x16x32_bf16 v[116:119], v[184:187], v[8:11], v[116:119]
    v_max3_f32 v243, v243, v60, v61
    v_max3_f32 v242, v242, v54, v55
    v_mfma_f32_16x16x32_bf16 v[120:123], v[188:191], v[0:3], v[120:123]
    ds_read_b64_tr_b16 v[172:173], v231 offset:57344
    ds_read_b64_tr_b16 v[174:175], v231 offset:61440
    v_max3_f32 v243, v243, v62, v63
    v_fma_f32 v250, v242, s26, v244
    v_mfma_f32_16x16x32_bf16 v[124:127], v[188:191], v[8:11], v[124:127]
    v_fma_f32 v251, v243, s26, v245
    v_max_f32 v250, v250, v251
    v_cmp_lt_f32 vcc, s35, v250
    s_cbranch_vccnz L_rareL3
L_backL3:
    s_waitcnt lgkmcnt(4)
    v_mfma_f32_16x16x32_bf16 v[64:67], v[160:163], v[16:19], v[64:67]
    ds_read_b64_tr_b16 v[176:177], v232 offset:57344
    ds_read_b64_tr_b16 v[178:179], v232 offset:61440
    v_fma_f32 v32, v32, s26, v244
    v_fma_f32 v33, v33, s26, v244
    v_mfma_f32_16x16x32_bf16 v[68:71], v[160:163], v[24:27], v[68:71]
    v_exp_f32 v32, v32
    v_fma_f32 v34, v34, s26, v244
    v_mfma_f32_16x16x32_bf16 v[72:75], v[164:167], v[16:19], v[72:75]
    ds_read_b64_tr_b16 v[180:181], v233 offset:57344
    ds_read_b64_tr_b16 v[182:183], v233 offset:61440
    v_exp_f32 v33, v33
    v_fma_f32 v35, v35, s26, v244
    v_mfma_f32_16x16x32_bf16 v[76:79], v[164:167], v[24:27], v[76:79]
    v_exp_f32 v34, v34
    v_add_f32 v246, v246, v32
    s_waitcnt lgkmcnt(4)
    v_mfma_f32_16x16x32_bf16 v[80:83], v[168:171], v[16:19], v[80:83]
    ds_read_b64_tr_b16 v[184:185], v234 offset:57344
    ds_read_b64_tr_b16 v[186:187], v234 offset:61440
    v_fma_f32 v36, v36, s26, v244
    v_exp_f32 v35, v35
    v_mfma_f32_16x16x32_bf16 v[84:87], v[168:171], v[24:27], v[84:87]
    v_add_f32 v246, v246, v33
    v_fma_f32 v37, v37, s26, v244
    v_exp_f32 v36, v36
    v_mfma_f32_16x16x32_bf16 v[88:91], v[172:175], v[16:19], v[88:91]
    ds_read_b64_tr_b16 v[188:189], v235 offset:57344
    ds_read_b64_tr_b16 v[190:191], v235 offset:61440
    v_add_f32 v246, v246, v34
    v_cvt_pk_bf16_f32 v32, v32, v33
    v_mfma_f32_16x16x32_bf16 v[92:95], v[172:175], v[24:27], v[92:95]
    v_fma_f32 v38, v38, s26, v244
    v_exp_f32 v37, v37
    s_waitcnt lgkmcnt(4)
    v_mfma_f32_16x16x32_bf16 v[96:99], v[176:179], v[16:19], v[96:99]
    v_add_f32 v246, v246, v35
    v_fma_f32 v39, v39, s26, v244
    v_mfma_f32_16x16x32_bf16 v[100:103], v[176:179], v[24:27], v[100:103]
    v_exp_f32 v38, v38
    v_add_f32 v246, v246, v36
    v_cvt_pk_bf16_f32 v33, v34, v35
    v_mfma_f32_16x16x32_bf16 v[104:107], v[180:183], v[16:19], v[104:107]
    v_exp_f32 v39, v39
    v_add_f32 v246, v246, v37
    v_mfma_f32_16x16x32_bf16 v[108:111], v[180:183], v[24:27], v[108:111]
    v_add_f32 v246, v246, v38
    v_cvt_pk_bf16_f32 v34, v36, v37
    s_waitcnt lgkmcnt(0)
    v_mfma_f32_16x16x32_bf16 v[112:115], v[184:187], v[16:19], v[112:115]
    v_add_f32 v246, v246, v39
    v_cvt_pk_bf16_f32 v35, v38, v39
    v_mfma_f32_16x16x32_bf16 v[116:119], v[184:187], v[24:27], v[116:119]
    v_mfma_f32_16x16x32_bf16 v[120:123], v[188:191], v[16:19], v[120:123]
    v_mfma_f32_16x16x32_bf16 v[124:127], v[188:191], v[24:27], v[124:127]
    s_mov_b32 s33, s20
    s_add_u32 s34, s20, 4096
    v_fma_f32 v40, v40, s26, v245
    v_fma_f32 v41, v41, s26, v245
    v_exp_f32 v40, v40
    v_fma_f32 v42, v42, s26, v245
    v_exp_f32 v41, v41
    v_fma_f32 v43, v43, s26, v245
    v_exp_f32 v42, v42
    v_add_f32 v247, v247, v40
    v_fma_f32 v44, v44, s26, v245
    v_exp_f32 v43, v43
    v_add_f32 v247, v247, v41
    v_fma_f32 v45, v45, s26, v245
    v_exp_f32 v44, v44
    v_add_f32 v247, v247, v42
    v_cvt_pk_bf16_f32 v40, v40, v41
    v_fma_f32 v46, v46, s26, v245
    v_exp_f32 v45, v45
    v_add_f32 v247, v247, v43
    v_fma_f32 v47, v47, s26, v245
    v_exp_f32 v46, v46
    v_add_f32 v247, v247, v44
    v_cvt_pk_bf16_f32 v41, v42, v43
    v_exp_f32 v47, v47
    v_add_f32 v247, v247, v45
    v_add_f32 v247, v247, v46
    v_cvt_pk_bf16_f32 v42, v44, v45
    v_add_f32 v247, v247, v47
    v_cvt_pk_bf16_f32 v43, v46, v47
    v_fma_f32 v48, v48, s26, v244
    v_fma_f32 v49, v49, s26, v244
    v_exp_f32 v48, v48
    v_fma_f32 v50, v50, s26, v244
    v_exp_f32 v49, v49
    v_fma_f32 v51, v51, s26, v244
    v_exp_f32 v50, v50
    v_add_f32 v246, v246, v48
    v_fma_f32 v52, v52, s26, v244
    v_exp_f32 v51, v51
    v_add_f32 v246, v246, v49
    v_fma_f32 v53, v53, s26, v244
    v_exp_f32 v52, v52
    v_add_f32 v246, v246, v50
    v_cvt_pk_bf16_f32 v48, v48, v49
    v_fma_f32 v54, v54, s26, v244
    v_exp_f32 v53, v53
    v_add_f32 v246, v246, v51
    v_fma_f32 v55, v55, s26, v244
    v_exp_f32 v54, v54
    v_add_f32 v246, v246, v52
    v_cvt_pk_bf16_f32 v49, v50, v51
    v_exp_f32 v55, v55
    v_add_f32 v246, v246, v53
    v_add_f32 v246, v246, v54
    v_cvt_pk_bf16_f32 v50, v52, v53
    v_add_f32 v246, v246, v55
    v_cvt_pk_bf16_f32 v51, v54, v55
    v_fma_f32 v56, v56, s26, v245
    v_fma_f32 v57, v57, s26, v245
    v_exp_f32 v56, v56
    v_fma_f32 v58, v58, s26, v245
    v_exp_f32 v57, v57
    v_fma_f32 v59, v59, s26, v245
    v_exp_f32 v58, v58
    v_add_f32 v247, v247, v56
    v_fma_f32 v60, v60, s26, v245
    v_exp_f32 v59, v59
    v_add_f32 v247, v247, v57
    v_fma_f32 v61, v61, s26, v245
    v_exp_f32 v60, v60
    v_add_f32 v247, v247, v58
    v_cvt_pk_bf16_f32 v56, v56, v57
    v_fma_f32 v62, v62, s26, v245
    v_exp_f32 v61, v61
    v_add_f32 v247, v247, v59
    v_fma_f32 v63, v63, s26, v245
    v_exp_f32 v62, v62
    v_add_f32 v247, v247, v60
    v_cvt_pk_bf16_f32 v57, v58, v59
    v_exp_f32 v63, v63
    v_add_f32 v247, v247, v61
    v_add_f32 v247, v247, v62
    v_cvt_pk_bf16_f32 v58, v60, v61
    v_add_f32 v247, v247, v63
    v_cvt_pk_bf16_f32 v59, v62, v63
    v_mov_b32 v250, v246
    v_mov_b32 v251, v247
    s_nop 0
    v_permlane16_swap_b32 v250, v246
    v_permlane16_swap_b32 v251, v247
    v_add_f32 v246, v246, v250
    v_add_f32 v247, v247, v251
    v_mov_b32 v250, v246
    v_mov_b32 v251, v247
    s_nop 0
    v_permlane32_swap_b32 v250, v246
    v_permlane32_swap_b32 v251, v247
    v_add_f32 v246, v246, v250
    v_add_f32 v247, v247, v251
    v_rcp_f32 v248, v246
    v_rcp_f32 v249, v247
    s_waitcnt vmcnt(4) lgkmcnt(0)
    s_barrier
    ds_read_b64_tr_b16 v[160:161], v228 offset:16384
    ds_read_b64_tr_b16 v[162:163], v228 offset:20480
    ds_read_b64_tr_b16 v[164:165], v228 offset:24576
    ds_read_b64_tr_b16 v[166:167], v228 offset:28672
    ds_read_b64_tr_b16 v[168:169], v229 offset:16384
    ds_read_b64_tr_b16 v[170:171], v229 offset:20480
    ds_read_b64_tr_b16 v[172:173], v229 offset:24576
    ds_read_b64_tr_b16 v[174:175], v229 offset:28672
    ds_read_b64_tr_b16 v[176:177], v230 offset:16384
    ds_read_b64_tr_b16 v[178:179], v230 offset:20480
    s_waitcnt lgkmcnt(8)
    v_mfma_f32_16x16x32_bf16 v[64:67], v[160:163], v[32:35], v[64:67]
    v_mfma_f32_16x16x32_bf16 v[68:71], v[160:163], v[40:43], v[68:71]
    ds_read_b64_tr_b16 v[180:181], v230 offset:24576
    ds_read_b64_tr_b16 v[182:183], v230 offset:28672
    s_waitcnt lgkmcnt(8)
    v_mfma_f32_16x16x32_bf16 v[64:67], v[164:167], v[48:51], v[64:67]
    v_mfma_f32_16x16x32_bf16 v[68:71], v[164:167], v[56:59], v[68:71]
    ds_read_b64_tr_b16 v[184:185], v231 offset:16384
    ds_read_b64_tr_b16 v[186:187], v231 offset:20480
    s_waitcnt lgkmcnt(8)
    v_mfma_f32_16x16x32_bf16 v[72:75], v[168:171], v[32:35], v[72:75]
    v_mfma_f32_16x16x32_bf16 v[76:79], v[168:171], v[40:43], v[76:79]
    ds_read_b64_tr_b16 v[188:189], v231 offset:24576
    ds_read_b64_tr_b16 v[190:191], v231 offset:28672
    s_waitcnt lgkmcnt(8)
    v_mfma_f32_16x16x32_bf16 v[72:75], v[172:175], v[48:51], v[72:75]
    v_mfma_f32_16x16x32_bf16 v[76:79], v[172:175], v[56:59], v[76:79]
    ds_read_b64_tr_b16 v[160:161], v232 offset:16384
    ds_read_b64_tr_b16 v[162:163], v232 offset:20480
    s_waitcnt lgkmcnt(8)
    v_mfma_f32_16x16x32_bf16 v[80:83], v[176:179], v[32:35], v[80:83]
    v_mfma_f32_16x16x32_bf16 v[84:87], v[176:179], v[40:43], v[84:87]
    ds_read_b64_tr_b16 v[164:165], v232 offset:24576
    ds_read_b64_tr_b16 v[166:167], v232 offset:28672
    v_mul_f32 v64, v64, v248
    v_mul_f32 v65, v65, v248
    v_mul_f32 v66, v66, v248
    v_mul_f32 v67, v67, v248
    v_cvt_pk_bf16_f32 v192, v64, v65
    v_cvt_pk_bf16_f32 v193, v66, v67
    ds_write_b64 v252, v[192:193] offset:0
    v_mul_f32 v68, v68, v249
    s_waitcnt lgkmcnt(9)
    v_mfma_f32_16x16x32_bf16 v[80:83], v[180:183], v[48:51], v[80:83]
    v_mfma_f32_16x16x32_bf16 v[84:87], v[180:183], v[56:59], v[84:87]
    ds_read_b64_tr_b16 v[168:169], v233 offset:16384
    ds_read_b64_tr_b16 v[170:171], v233 offset:20480
    v_mul_f32 v69, v69, v249
    v_mul_f32 v70, v70, v249
    v_mul_f32 v71, v71, v249
    v_cvt_pk_bf16_f32 v208, v68, v69
    v_cvt_pk_bf16_f32 v209, v70, v71
    s_waitcnt lgkmcnt(9)
    v_mfma_f32_16x16x32_bf16 v[88:91], v[184:187], v[32:35], v[88:91]
    v_mfma_f32_16x16x32_bf16 v[92:95], v[184:187], v[40:43], v[92:95]
    ds_read_b64_tr_b16 v[172:173], v233 offset:24576
    ds_read_b64_tr_b16 v[174:175], v233 offset:28672
    v_mul_f32 v72, v72, v248
    v_mul_f32 v73, v73, v248
    v_mul_f32 v74, v74, v248
    v_mul_f32 v75, v75, v248
    v_cvt_pk_bf16_f32 v194, v72, v73
    v_cvt_pk_bf16_f32 v195, v74, v75
    v_xor_b32 v250, 32, v252
    ds_write_b64 v250, v[194:195] offset:0
    s_waitcnt lgkmcnt(10)
    v_mfma_f32_16x16x32_bf16 v[88:91], v[188:191], v[48:51], v[88:91]
    v_mfma_f32_16x16x32_bf16 v[92:95], v[188:191], v[56:59], v[92:95]
    ds_read_b64_tr_b16 v[176:177], v234 offset:16384
    ds_read_b64_tr_b16 v[178:179], v234 offset:20480
    v_mul_f32 v76, v76, v249
    v_mul_f32 v77, v77, v249
    v_mul_f32 v78, v78, v249
    v_mul_f32 v79, v79, v249
    v_cvt_pk_bf16_f32 v210, v76, v77
    v_cvt_pk_bf16_f32 v211, v78, v79
    s_waitcnt lgkmcnt(10)
    v_mfma_f32_16x16x32_bf16 v[96:99], v[160:163], v[32:35], v[96:99]
    v_mfma_f32_16x16x32_bf16 v[100:103], v[160:163], v[40:43], v[100:103]
    ds_read_b64_tr_b16 v[180:181], v234 offset:24576
    ds_read_b64_tr_b16 v[182:183], v234 offset:28672
    v_mul_f32 v80, v80, v248
    v_mul_f32 v81, v81, v248
    v_mul_f32 v82, v82, v248
    v_mul_f32 v83, v83, v248
    v_cvt_pk_bf16_f32 v196, v80, v81
    v_cvt_pk_bf16_f32 v197, v82, v83
    v_xor_b32 v250, 64, v252
    ds_write_b64 v250, v[196:197] offset:0
    s_waitcnt lgkmcnt(11)
    v_mfma_f32_16x16x32_bf16 v[96:99], v[164:167], v[48:51], v[96:99]
    v_mfma_f32_16x16x32_bf16 v[100:103], v[164:167], v[56:59], v[100:103]
    ds_read_b64_tr_b16 v[184:185], v235 offset:16384
    ds_read_b64_tr_b16 v[186:187], v235 offset:20480
    v_mul_f32 v84, v84, v249
    v_mul_f32 v85, v85, v249
    v_mul_f32 v86, v86, v249
    v_mul_f32 v87, v87, v249
    v_cvt_pk_bf16_f32 v212, v84, v85
    v_cvt_pk_bf16_f32 v213, v86, v87
    s_waitcnt lgkmcnt(10)
    v_mfma_f32_16x16x32_bf16 v[104:107], v[168:171], v[32:35], v[104:107]
    v_mfma_f32_16x16x32_bf16 v[108:111], v[168:171], v[40:43], v[108:111]
    ds_read_b64_tr_b16 v[188:189], v235 offset:24576
    ds_read_b64_tr_b16 v[190:191], v235 offset:28672
    v_mul_f32 v88, v88, v248
    v_mul_f32 v89, v89, v248
    v_mul_f32 v90, v90, v248
    v_mul_f32 v91, v91, v248
    v_cvt_pk_bf16_f32 v198, v88, v89
    v_cvt_pk_bf16_f32 v199, v90, v91
    v_xor_b32 v250, 96, v252
    ds_write_b64 v250, v[198:199] offset:0
    s_waitcnt lgkmcnt(11)
    v_mfma_f32_16x16x32_bf16 v[104:107], v[172:175], v[48:51], v[104:107]
    v_mfma_f32_16x16x32_bf16 v[108:111], v[172:175], v[56:59], v[108:111]
    v_mul_f32 v92, v92, v249
    v_mul_f32 v93, v93, v249
    v_mul_f32 v94, v94, v249
    v_mul_f32 v95, v95, v249
    v_cvt_pk_bf16_f32 v214, v92, v93
    v_cvt_pk_bf16_f32 v215, v94, v95
    s_waitcnt lgkmcnt(8)
    v_mfma_f32_16x16x32_bf16 v[112:115], v[176:179], v[32:35], v[112:115]
    v_mfma_f32_16x16x32_bf16 v[116:119], v[176:179], v[40:43], v[116:119]
    v_mul_f32 v96, v96, v248
    v_mul_f32 v97, v97, v248
    v_mul_f32 v98, v98, v248
    v_mul_f32 v99, v99, v248
    v_cvt_pk_bf16_f32 v200, v96, v97
    v_cvt_pk_bf16_f32 v201, v98, v99
    ds_write_b64 v252, v[200:201] offset:128
    v_mul_f32 v100, v100, v249
    s_waitcnt lgkmcnt(7)
    v_mfma_f32_16x16x32_bf16 v[112:115], v[180:183], v[48:51], v[112:115]
    v_mfma_f32_16x16x32_bf16 v[116:119], v[180:183], v[56:59], v[116:119]
    v_mul_f32 v101, v101, v249
    v_mul_f32 v102, v102, v249
    v_mul_f32 v103, v103, v249
    v_cvt_pk_bf16_f32 v216, v100, v101
    v_cvt_pk_bf16_f32 v217, v102, v103
    s_waitcnt lgkmcnt(4)
    v_mfma_f32_16x16x32_bf16 v[120:123], v[184:187], v[32:35], v[120:123]
    v_mfma_f32_16x16x32_bf16 v[124:127], v[184:187], v[40:43], v[124:127]
    v_mul_f32 v104, v104, v248
    v_mul_f32 v105, v105, v248
    v_mul_f32 v106, v106, v248
    v_mul_f32 v107, v107, v248
    v_cvt_pk_bf16_f32 v202, v104, v105
    v_cvt_pk_bf16_f32 v203, v106, v107
    v_xor_b32 v250, 32, v252
    ds_write_b64 v250, v[202:203] offset:128
    s_waitcnt lgkmcnt(3)
    v_mfma_f32_16x16x32_bf16 v[120:123], v[188:191], v[48:51], v[120:123]
    v_mfma_f32_16x16x32_bf16 v[124:127], v[188:191], v[56:59], v[124:127]
    v_mul_f32 v108, v108, v249
    v_mul_f32 v109, v109, v249
    v_mul_f32 v110, v110, v249
    v_mul_f32 v111, v111, v249
    v_cvt_pk_bf16_f32 v218, v108, v109
    v_cvt_pk_bf16_f32 v219, v110, v111
    v_mul_f32 v112, v112, v248
    v_mul_f32 v113, v113, v248
    v_mul_f32 v114, v114, v248
    v_mul_f32 v115, v115, v248
    v_cvt_pk_bf16_f32 v204, v112, v113
    v_cvt_pk_bf16_f32 v205, v114, v115
    v_xor_b32 v250, 64, v252
    ds_write_b64 v250, v[204:205] offset:128
    v_mul_f32 v116, v116, v249
    v_mul_f32 v117, v117, v249
    v_mul_f32 v118, v118, v249
    v_mul_f32 v119, v119, v249
    v_cvt_pk_bf16_f32 v220, v116, v117
    v_cvt_pk_bf16_f32 v221, v118, v119
    v_mul_f32 v120, v120, v248
    v_mul_f32 v121, v121, v248
    v_mul_f32 v122, v122, v248
    v_mul_f32 v123, v123, v248
    v_cvt_pk_bf16_f32 v206, v120, v121
    v_cvt_pk_bf16_f32 v207, v122, v123
    v_xor_b32 v250, 96, v252
    ds_write_b64 v250, v[206:207] offset:128
    v_mul_f32 v124, v124, v249
    v_mul_f32 v125, v125, v249
    v_mul_f32 v126, v126, v249
    v_mul_f32 v127, v127, v249
    v_cvt_pk_bf16_f32 v222, v124, v125
    v_cvt_pk_bf16_f32 v223, v126, v127
    ds_read_b128 v[192:195], v240 offset:0
    ds_read_b128 v[196:199], v240 offset:1024
    ds_read_b128 v[200:203], v240 offset:2048
    ds_read_b128 v[204:207], v240 offset:3072
    ds_write_b64 v252, v[208:209] offset:0
    v_xor_b32 v250, 32, v252
    ds_write_b64 v250, v[210:211] offset:0
    v_xor_b32 v250, 64, v252
    ds_write_b64 v250, v[212:213] offset:0
    v_xor_b32 v250, 96, v252
    ds_write_b64 v250, v[214:215] offset:0
    ds_write_b64 v252, v[216:217] offset:128
    v_xor_b32 v250, 32, v252
    ds_write_b64 v250, v[218:219] offset:128
    v_xor_b32 v250, 64, v252
    s_waitcnt lgkmcnt(14)
    ds_write_b64 v250, v[220:221] offset:128
    v_xor_b32 v250, 96, v252
    s_waitcnt lgkmcnt(14)
    ds_write_b64 v250, v[222:223] offset:128
    s_waitcnt lgkmcnt(14)
    ds_read_b128 v[208:211], v240 offset:0
    s_waitcnt lgkmcnt(14)
    ds_read_b128 v[212:215], v240 offset:1024
    s_waitcnt lgkmcnt(14)
    ds_read_b128 v[216:219], v240 offset:2048
    s_waitcnt lgkmcnt(14)
    ds_read_b128 v[220:223], v240 offset:3072
    s_nop 1
    buffer_store_dwordx4 v[192:195], v241, s[16:19], s33 offen sc1
    s_waitcnt lgkmcnt(14)
    buffer_store_dwordx4 v[196:199], v253, s[16:19], s33 offen offset:1024 sc1
    s_waitcnt lgkmcnt(13)
    buffer_store_dwordx4 v[200:203], v241, s[16:19], s33 offen offset:2048 sc1
    s_waitcnt lgkmcnt(12)
    buffer_store_dwordx4 v[204:207], v253, s[16:19], s33 offen offset:3072 sc1
    s_waitcnt lgkmcnt(3)
    buffer_store_dwordx4 v[208:211], v241, s[16:19], s34 offen sc1
    s_waitcnt lgkmcnt(2)
    buffer_store_dwordx4 v[212:215], v253, s[16:19], s34 offen offset:1024 sc1
    s_waitcnt lgkmcnt(1)
    buffer_store_dwordx4 v[216:219], v241, s[16:19], s34 offen offset:2048 sc1
    s_waitcnt lgkmcnt(0)
    buffer_store_dwordx4 v[220:223], v253, s[16:19], s34 offen offset:3072 sc1
    s_waitcnt vmcnt(0)
    s_endpgm
L_rare1:
    s_nop 15
    v_mov_b32 v250, v242
    v_mov_b32 v251, v243
    s_nop 1
    v_permlane16_swap_b32 v250, v242
    s_nop 0
    v_permlane16_swap_b32 v251, v243
    s_nop 0
    v_max_f32 v242, v242, v250
    v_max_f32 v243, v243, v251
    v_mov_b32 v250, v242
    v_mov_b32 v251, v243
    s_nop 1
    v_permlane32_swap_b32 v250, v242
    s_nop 0
    v_permlane32_swap_b32 v251, v243
    s_nop 0
    v_max_f32 v242, v242, v250
    v_max_f32 v243, v243, v251
    v_mul_f32 v250, s31, v242
    v_min_f32 v250, v250, v244
    v_sub_f32 v251, v250, v244
    v_exp_f32 v251, v251
    v_mov_b32 v244, v250
    v_mul_f32 v246, v246, v251
    v_mul_f32 v64, v64, v251
    v_mul_f32 v65, v65, v251
    v_mul_f32 v66, v66, v251
    v_mul_f32 v67, v67, v251
    v_mul_f32 v72, v72, v251
    v_mul_f32 v73, v73, v251
    v_mul_f32 v74, v74, v251
    v_mul_f32 v75, v75, v251
    v_mul_f32 v80, v80, v251
    v_mul_f32 v81, v81, v251
    v_mul_f32 v82, v82, v251
    v_mul_f32 v83, v83, v251
    v_mul_f32 v88, v88, v251
    v_mul_f32 v89, v89, v251
    v_mul_f32 v90, v90, v251
    v_mul_f32 v91, v91, v251
    v_mul_f32 v96, v96, v251
    v_mul_f32 v97, v97, v251
    v_mul_f32 v98, v98, v251
    v_mul_f32 v99, v99, v251
    v_mul_f32 v104, v104, v251
    v_mul_f32 v105, v105, v251
    v_mul_f32 v106, v106, v251
    v_mul_f32 v107, v107, v251
    v_mul_f32 v112, v112, v251
    v_mul_f32 v113, v113, v251
    v_mul_f32 v114, v114, v251
    v_mul_f32 v115, v115, v251
    v_mul_f32 v120, v120, v251
    v_mul_f32 v121, v121, v251
    v_mul_f32 v122, v122, v251
    v_mul_f32 v123, v123, v251
    v_lshlrev_b32 v4, 16, v0
    v_and_b32 v5, 0xffff0000, v0
    v_mul_f32 v4, v4, v251
    v_mul_f32 v5, v5, v251
    v_cvt_pk_bf16_f32 v0, v4, v5
    v_lshlrev_b32 v4, 16, v1
    v_and_b32 v5, 0xffff0000, v1
    v_mul_f32 v4, v4, v251
    v_mul_f32 v5, v5, v251
    v_cvt_pk_bf16_f32 v1, v4, v5
    v_lshlrev_b32 v4, 16, v2
    v_and_b32 v5, 0xffff0000, v2
    v_mul_f32 v4, v4, v251
    v_mul_f32 v5, v5, v251
    v_cvt_pk_bf16_f32 v2, v4, v5
    v_lshlrev_b32 v4, 16, v3
    v_and_b32 v5, 0xffff0000, v3
    v_mul_f32 v4, v4, v251
    v_mul_f32 v5, v5, v251
    v_cvt_pk_bf16_f32 v3, v4, v5
    v_lshlrev_b32 v20, 16, v16
    v_and_b32 v21, 0xffff0000, v16
    v_mul_f32 v20, v20, v251
    v_mul_f32 v21, v21, v251
    v_cvt_pk_bf16_f32 v16, v20, v21
    v_lshlrev_b32 v20, 16, v17
    v_and_b32 v21, 0xffff0000, v17
    v_mul_f32 v20, v20, v251
    v_mul_f32 v21, v21, v251
    v_cvt_pk_bf16_f32 v17, v20, v21
    v_lshlrev_b32 v20, 16, v18
    v_and_b32 v21, 0xffff0000, v18
    v_mul_f32 v20, v20, v251
    v_mul_f32 v21, v21, v251
    v_cvt_pk_bf16_f32 v18, v20, v21
    v_lshlrev_b32 v20, 16, v19
    v_and_b32 v21, 0xffff0000, v19
    v_mul_f32 v20, v20, v251
    v_mul_f32 v21, v21, v251
    v_cvt_pk_bf16_f32 v19, v20, v21
    v_mul_f32 v250, s31, v243
    v_min_f32 v250, v250, v245
    v_sub_f32 v251, v250, v245
    v_exp_f32 v251, v251
    v_mov_b32 v245, v250
    v_mul_f32 v247, v247, v251
    v_mul_f32 v68, v68, v251
    v_mul_f32 v69, v69, v251
    v_mul_f32 v70, v70, v251
    v_mul_f32 v71, v71, v251
    v_mul_f32 v76, v76, v251
    v_mul_f32 v77, v77, v251
    v_mul_f32 v78, v78, v251
    v_mul_f32 v79, v79, v251
    v_mul_f32 v84, v84, v251
    v_mul_f32 v85, v85, v251
    v_mul_f32 v86, v86, v251
    v_mul_f32 v87, v87, v251
    v_mul_f32 v92, v92, v251
    v_mul_f32 v93, v93, v251
    v_mul_f32 v94, v94, v251
    v_mul_f32 v95, v95, v251
    v_mul_f32 v100, v100, v251
    v_mul_f32 v101, v101, v251
    v_mul_f32 v102, v102, v251
    v_mul_f32 v103, v103, v251
    v_mul_f32 v108, v108, v251
    v_mul_f32 v109, v109, v251
    v_mul_f32 v110, v110, v251
    v_mul_f32 v111, v111, v251
    v_mul_f32 v116, v116, v251
    v_mul_f32 v117, v117, v251
    v_mul_f32 v118, v118, v251
    v_mul_f32 v119, v119, v251
    v_mul_f32 v124, v124, v251
    v_mul_f32 v125, v125, v251
    v_mul_f32 v126, v126, v251
    v_mul_f32 v127, v127, v251
    v_lshlrev_b32 v12, 16, v8
    v_and_b32 v13, 0xffff0000, v8
    v_mul_f32 v12, v12, v251
    v_mul_f32 v13, v13, v251
    v_cvt_pk_bf16_f32 v8, v12, v13
    v_lshlrev_b32 v12, 16, v9
    v_and_b32 v13, 0xffff0000, v9
    v_mul_f32 v12, v12, v251
    v_mul_f32 v13, v13, v251
    v_cvt_pk_bf16_f32 v9, v12, v13
    v_lshlrev_b32 v12, 16, v10
    v_and_b32 v13, 0xffff0000, v10
    v_mul_f32 v12, v12, v251
    v_mul_f32 v13, v13, v251
    v_cvt_pk_bf16_f32 v10, v12, v13
    v_lshlrev_b32 v12, 16, v11
    v_and_b32 v13, 0xffff0000, v11
    v_mul_f32 v12, v12, v251
    v_mul_f32 v13, v13, v251
    v_cvt_pk_bf16_f32 v11, v12, v13
    v_lshlrev_b32 v28, 16, v24
    v_and_b32 v29, 0xffff0000, v24
    v_mul_f32 v28, v28, v251
    v_mul_f32 v29, v29, v251
    v_cvt_pk_bf16_f32 v24, v28, v29
    v_lshlrev_b32 v28, 16, v25
    v_and_b32 v29, 0xffff0000, v25
    v_mul_f32 v28, v28, v251
    v_mul_f32 v29, v29, v251
    v_cvt_pk_bf16_f32 v25, v28, v29
    v_lshlrev_b32 v28, 16, v26
    v_and_b32 v29, 0xffff0000, v26
    v_mul_f32 v28, v28, v251
    v_mul_f32 v29, v29, v251
    v_cvt_pk_bf16_f32 v26, v28, v29
    v_lshlrev_b32 v28, 16, v27
    v_and_b32 v29, 0xffff0000, v27
    v_mul_f32 v28, v28, v251
    v_mul_f32 v29, v29, v251
    v_cvt_pk_bf16_f32 v27, v28, v29
    s_nop 3
    s_branch L_back1
L_rare2:
    s_nop 15
    v_mov_b32 v250, v242
    v_mov_b32 v251, v243
    s_nop 1
    v_permlane16_swap_b32 v250, v242
    s_nop 0
    v_permlane16_swap_b32 v251, v243
    s_nop 0
    v_max_f32 v242, v242, v250
    v_max_f32 v243, v243, v251
    v_mov_b32 v250, v242
    v_mov_b32 v251, v243
    s_nop 1
    v_permlane32_swap_b32 v250, v242
    s_nop 0
    v_permlane32_swap_b32 v251, v243
    s_nop 0
    v_max_f32 v242, v242, v250
    v_max_f32 v243, v243, v251
    v_mul_f32 v250, s31, v242
    v_min_f32 v250, v250, v244
    v_sub_f32 v251, v250, v244
    v_exp_f32 v251, v251
    v_mov_b32 v244, v250
    v_mul_f32 v246, v246, v251
    v_mul_f32 v64, v64, v251
    v_mul_f32 v65, v65, v251
    v_mul_f32 v66, v66, v251
    v_mul_f32 v67, v67, v251
    v_mul_f32 v72, v72, v251
    v_mul_f32 v73, v73, v251
    v_mul_f32 v74, v74, v251
    v_mul_f32 v75, v75, v251
    v_mul_f32 v80, v80, v251
    v_mul_f32 v81, v81, v251
    v_mul_f32 v82, v82, v251
    v_mul_f32 v83, v83, v251
    v_mul_f32 v88, v88, v251
    v_mul_f32 v89, v89, v251
    v_mul_f32 v90, v90, v251
    v_mul_f32 v91, v91, v251
    v_mul_f32 v96, v96, v251
    v_mul_f32 v97, v97, v251
    v_mul_f32 v98, v98, v251
    v_mul_f32 v99, v99, v251
    v_mul_f32 v104, v104, v251
    v_mul_f32 v105, v105, v251
    v_mul_f32 v106, v106, v251
    v_mul_f32 v107, v107, v251
    v_mul_f32 v112, v112, v251
    v_mul_f32 v113, v113, v251
    v_mul_f32 v114, v114, v251
    v_mul_f32 v115, v115, v251
    v_mul_f32 v120, v120, v251
    v_mul_f32 v121, v121, v251
    v_mul_f32 v122, v122, v251
    v_mul_f32 v123, v123, v251
    v_lshlrev_b32 v36, 16, v32
    v_and_b32 v37, 0xffff0000, v32
    v_mul_f32 v36, v36, v251
    v_mul_f32 v37, v37, v251
    v_cvt_pk_bf16_f32 v32, v36, v37
    v_lshlrev_b32 v36, 16, v33
    v_and_b32 v37, 0xffff0000, v33
    v_mul_f32 v36, v36, v251
    v_mul_f32 v37, v37, v251
    v_cvt_pk_bf16_f32 v33, v36, v37
    v_lshlrev_b32 v36, 16, v34
    v_and_b32 v37, 0xffff0000, v34
    v_mul_f32 v36, v36, v251
    v_mul_f32 v37, v37, v251
    v_cvt_pk_bf16_f32 v34, v36, v37
    v_lshlrev_b32 v36, 16, v35
    v_and_b32 v37, 0xffff0000, v35
    v_mul_f32 v36, v36, v251
    v_mul_f32 v37, v37, v251
    v_cvt_pk_bf16_f32 v35, v36, v37
    v_lshlrev_b32 v52, 16, v48
    v_and_b32 v53, 0xffff0000, v48
    v_mul_f32 v52, v52, v251
    v_mul_f32 v53, v53, v251
    v_cvt_pk_bf16_f32 v48, v52, v53
    v_lshlrev_b32 v52, 16, v49
    v_and_b32 v53, 0xffff0000, v49
    v_mul_f32 v52, v52, v251
    v_mul_f32 v53, v53, v251
    v_cvt_pk_bf16_f32 v49, v52, v53
    v_lshlrev_b32 v52, 16, v50
    v_and_b32 v53, 0xffff0000, v50
    v_mul_f32 v52, v52, v251
    v_mul_f32 v53, v53, v251
    v_cvt_pk_bf16_f32 v50, v52, v53
    v_lshlrev_b32 v52, 16, v51
    v_and_b32 v53, 0xffff0000, v51
    v_mul_f32 v52, v52, v251
    v_mul_f32 v53, v53, v251
    v_cvt_pk_bf16_f32 v51, v52, v53
    v_mul_f32 v250, s31, v243
    v_min_f32 v250, v250, v245
    v_sub_f32 v251, v250, v245
    v_exp_f32 v251, v251
    v_mov_b32 v245, v250
    v_mul_f32 v247, v247, v251
    v_mul_f32 v68, v68, v251
    v_mul_f32 v69, v69, v251
    v_mul_f32 v70, v70, v251
    v_mul_f32 v71, v71, v251
    v_mul_f32 v76, v76, v251
    v_mul_f32 v77, v77, v251
    v_mul_f32 v78, v78, v251
    v_mul_f32 v79, v79, v251
    v_mul_f32 v84, v84, v251
    v_mul_f32 v85, v85, v251
    v_mul_f32 v86, v86, v251
    v_mul_f32 v87, v87, v251
    v_mul_f32 v92, v92, v251
    v_mul_f32 v93, v93, v251
    v_mul_f32 v94, v94, v251
    v_mul_f32 v95, v95, v251
    v_mul_f32 v100, v100, v251
    v_mul_f32 v101, v101, v251
    v_mul_f32 v102, v102, v251
    v_mul_f32 v103, v103, v251
    v_mul_f32 v108, v108, v251
    v_mul_f32 v109, v109, v251
    v_mul_f32 v110, v110, v251
    v_mul_f32 v111, v111, v251
    v_mul_f32 v116, v116, v251
    v_mul_f32 v117, v117, v251
    v_mul_f32 v118, v118, v251
    v_mul_f32 v119, v119, v251
    v_mul_f32 v124, v124, v251
    v_mul_f32 v125, v125, v251
    v_mul_f32 v126, v126, v251
    v_mul_f32 v127, v127, v251
    v_lshlrev_b32 v44, 16, v40
    v_and_b32 v45, 0xffff0000, v40
    v_mul_f32 v44, v44, v251
    v_mul_f32 v45, v45, v251
    v_cvt_pk_bf16_f32 v40, v44, v45
    v_lshlrev_b32 v44, 16, v41
    v_and_b32 v45, 0xffff0000, v41
    v_mul_f32 v44, v44, v251
    v_mul_f32 v45, v45, v251
    v_cvt_pk_bf16_f32 v41, v44, v45
    v_lshlrev_b32 v44, 16, v42
    v_and_b32 v45, 0xffff0000, v42
    v_mul_f32 v44, v44, v251
    v_mul_f32 v45, v45, v251
    v_cvt_pk_bf16_f32 v42, v44, v45
    v_lshlrev_b32 v44, 16, v43
    v_and_b32 v45, 0xffff0000, v43
    v_mul_f32 v44, v44, v251
    v_mul_f32 v45, v45, v251
    v_cvt_pk_bf16_f32 v43, v44, v45
    v_lshlrev_b32 v60, 16, v56
    v_and_b32 v61, 0xffff0000, v56
    v_mul_f32 v60, v60, v251
    v_mul_f32 v61, v61, v251
    v_cvt_pk_bf16_f32 v56, v60, v61
    v_lshlrev_b32 v60, 16, v57
    v_and_b32 v61, 0xffff0000, v57
    v_mul_f32 v60, v60, v251
    v_mul_f32 v61, v61, v251
    v_cvt_pk_bf16_f32 v57, v60, v61
    v_lshlrev_b32 v60, 16, v58
    v_and_b32 v61, 0xffff0000, v58
    v_mul_f32 v60, v60, v251
    v_mul_f32 v61, v61, v251
    v_cvt_pk_bf16_f32 v58, v60, v61
    v_lshlrev_b32 v60, 16, v59
    v_and_b32 v61, 0xffff0000, v59
    v_mul_f32 v60, v60, v251
    v_mul_f32 v61, v61, v251
    v_cvt_pk_bf16_f32 v59, v60, v61
    s_nop 3
    s_branch L_back2
L_rare3:
    s_nop 15
    v_mov_b32 v250, v242
    v_mov_b32 v251, v243
    s_nop 1
    v_permlane16_swap_b32 v250, v242
    s_nop 0
    v_permlane16_swap_b32 v251, v243
    s_nop 0
    v_max_f32 v242, v242, v250
    v_max_f32 v243, v243, v251
    v_mov_b32 v250, v242
    v_mov_b32 v251, v243
    s_nop 1
    v_permlane32_swap_b32 v250, v242
    s_nop 0
    v_permlane32_swap_b32 v251, v243
    s_nop 0
    v_max_f32 v242, v242, v250
    v_max_f32 v243, v243, v251
    v_mul_f32 v250, s31, v242
    v_min_f32 v250, v250, v244
    v_sub_f32 v251, v250, v244
    v_exp_f32 v251, v251
    v_mov_b32 v244, v250
    v_mul_f32 v246, v246, v251
    v_mul_f32 v64, v64, v251
    v_mul_f32 v65, v65, v251
    v_mul_f32 v66, v66, v251
    v_mul_f32 v67, v67, v251
    v_mul_f32 v72, v72, v251
    v_mul_f32 v73, v73, v251
    v_mul_f32 v74, v74, v251
    v_mul_f32 v75, v75, v251
    v_mul_f32 v80, v80, v251
    v_mul_f32 v81, v81, v251
    v_mul_f32 v82, v82, v251
    v_mul_f32 v83, v83, v251
    v_mul_f32 v88, v88, v251
    v_mul_f32 v89, v89, v251
    v_mul_f32 v90, v90, v251
    v_mul_f32 v91, v91, v251
    v_mul_f32 v96, v96, v251
    v_mul_f32 v97, v97, v251
    v_mul_f32 v98, v98, v251
    v_mul_f32 v99, v99, v251
    v_mul_f32 v104, v104, v251
    v_mul_f32 v105, v105, v251
    v_mul_f32 v106, v106, v251
    v_mul_f32 v107, v107, v251
    v_mul_f32 v112, v112, v251
    v_mul_f32 v113, v113, v251
    v_mul_f32 v114, v114, v251
    v_mul_f32 v115, v115, v251
    v_mul_f32 v120, v120, v251
    v_mul_f32 v121, v121, v251
    v_mul_f32 v122, v122, v251
    v_mul_f32 v123, v123, v251
    v_lshlrev_b32 v4, 16, v0
    v_and_b32 v5, 0xffff0000, v0
    v_mul_f32 v4, v4, v251
    v_mul_f32 v5, v5, v251
    v_cvt_pk_bf16_f32 v0, v4, v5
    v_lshlrev_b32 v4, 16, v1
    v_and_b32 v5, 0xffff0000, v1
    v_mul_f32 v4, v4, v251
    v_mul_f32 v5, v5, v251
    v_cvt_pk_bf16_f32 v1, v4, v5
    v_lshlrev_b32 v4, 16, v2
    v_and_b32 v5, 0xffff0000, v2
    v_mul_f32 v4, v4, v251
    v_mul_f32 v5, v5, v251
    v_cvt_pk_bf16_f32 v2, v4, v5
    v_lshlrev_b32 v4, 16, v3
    v_and_b32 v5, 0xffff0000, v3
    v_mul_f32 v4, v4, v251
    v_mul_f32 v5, v5, v251
    v_cvt_pk_bf16_f32 v3, v4, v5
    v_lshlrev_b32 v20, 16, v16
    v_and_b32 v21, 0xffff0000, v16
    v_mul_f32 v20, v20, v251
    v_mul_f32 v21, v21, v251
    v_cvt_pk_bf16_f32 v16, v20, v21
    v_lshlrev_b32 v20, 16, v17
    v_and_b32 v21, 0xffff0000, v17
    v_mul_f32 v20, v20, v251
    v_mul_f32 v21, v21, v251
    v_cvt_pk_bf16_f32 v17, v20, v21
    v_lshlrev_b32 v20, 16, v18
    v_and_b32 v21, 0xffff0000, v18
    v_mul_f32 v20, v20, v251
    v_mul_f32 v21, v21, v251
    v_cvt_pk_bf16_f32 v18, v20, v21
    v_lshlrev_b32 v20, 16, v19
    v_and_b32 v21, 0xffff0000, v19
    v_mul_f32 v20, v20, v251
    v_mul_f32 v21, v21, v251
    v_cvt_pk_bf16_f32 v19, v20, v21
    v_mul_f32 v250, s31, v243
    v_min_f32 v250, v250, v245
    v_sub_f32 v251, v250, v245
    v_exp_f32 v251, v251
    v_mov_b32 v245, v250
    v_mul_f32 v247, v247, v251
    v_mul_f32 v68, v68, v251
    v_mul_f32 v69, v69, v251
    v_mul_f32 v70, v70, v251
    v_mul_f32 v71, v71, v251
    v_mul_f32 v76, v76, v251
    v_mul_f32 v77, v77, v251
    v_mul_f32 v78, v78, v251
    v_mul_f32 v79, v79, v251
    v_mul_f32 v84, v84, v251
    v_mul_f32 v85, v85, v251
    v_mul_f32 v86, v86, v251
    v_mul_f32 v87, v87, v251
    v_mul_f32 v92, v92, v251
    v_mul_f32 v93, v93, v251
    v_mul_f32 v94, v94, v251
    v_mul_f32 v95, v95, v251
    v_mul_f32 v100, v100, v251
    v_mul_f32 v101, v101, v251
    v_mul_f32 v102, v102, v251
    v_mul_f32 v103, v103, v251
    v_mul_f32 v108, v108, v251
    v_mul_f32 v109, v109, v251
    v_mul_f32 v110, v110, v251
    v_mul_f32 v111, v111, v251
    v_mul_f32 v116, v116, v251
    v_mul_f32 v117, v117, v251
    v_mul_f32 v118, v118, v251
    v_mul_f32 v119, v119, v251
    v_mul_f32 v124, v124, v251
    v_mul_f32 v125, v125, v251
    v_mul_f32 v126, v126, v251
    v_mul_f32 v127, v127, v251
    v_lshlrev_b32 v12, 16, v8
    v_and_b32 v13, 0xffff0000, v8
    v_mul_f32 v12, v12, v251
    v_mul_f32 v13, v13, v251
    v_cvt_pk_bf16_f32 v8, v12, v13
    v_lshlrev_b32 v12, 16, v9
    v_and_b32 v13, 0xffff0000, v9
    v_mul_f32 v12, v12, v251
    v_mul_f32 v13, v13, v251
    v_cvt_pk_bf16_f32 v9, v12, v13
    v_lshlrev_b32 v12, 16, v10
    v_and_b32 v13, 0xffff0000, v10
    v_mul_f32 v12, v12, v251
    v_mul_f32 v13, v13, v251
    v_cvt_pk_bf16_f32 v10, v12, v13
    v_lshlrev_b32 v12, 16, v11
    v_and_b32 v13, 0xffff0000, v11
    v_mul_f32 v12, v12, v251
    v_mul_f32 v13, v13, v251
    v_cvt_pk_bf16_f32 v11, v12, v13
    v_lshlrev_b32 v28, 16, v24
    v_and_b32 v29, 0xffff0000, v24
    v_mul_f32 v28, v28, v251
    v_mul_f32 v29, v29, v251
    v_cvt_pk_bf16_f32 v24, v28, v29
    v_lshlrev_b32 v28, 16, v25
    v_and_b32 v29, 0xffff0000, v25
    v_mul_f32 v28, v28, v251
    v_mul_f32 v29, v29, v251
    v_cvt_pk_bf16_f32 v25, v28, v29
    v_lshlrev_b32 v28, 16, v26
    v_and_b32 v29, 0xffff0000, v26
    v_mul_f32 v28, v28, v251
    v_mul_f32 v29, v29, v251
    v_cvt_pk_bf16_f32 v26, v28, v29
    v_lshlrev_b32 v28, 16, v27
    v_and_b32 v29, 0xffff0000, v27
    v_mul_f32 v28, v28, v251
    v_mul_f32 v29, v29, v251
    v_cvt_pk_bf16_f32 v27, v28, v29
    s_nop 3
    s_branch L_back3
L_rareL1:
    s_nop 15
    v_mov_b32 v250, v242
    v_mov_b32 v251, v243
    s_nop 1
    v_permlane16_swap_b32 v250, v242
    s_nop 0
    v_permlane16_swap_b32 v251, v243
    s_nop 0
    v_max_f32 v242, v242, v250
    v_max_f32 v243, v243, v251
    v_mov_b32 v250, v242
    v_mov_b32 v251, v243
    s_nop 1
    v_permlane32_swap_b32 v250, v242
    s_nop 0
    v_permlane32_swap_b32 v251, v243
    s_nop 0
    v_max_f32 v242, v242, v250
    v_max_f32 v243, v243, v251
    v_mul_f32 v250, s31, v242
    v_min_f32 v250, v250, v244
    v_sub_f32 v251, v250, v244
    v_exp_f32 v251, v251
    v_mov_b32 v244, v250
    v_mul_f32 v246, v246, v251
    v_mul_f32 v64, v64, v251
    v_mul_f32 v65, v65, v251
    v_mul_f32 v66, v66, v251
    v_mul_f32 v67, v67, v251
    v_mul_f32 v72, v72, v251
    v_mul_f32 v73, v73, v251
    v_mul_f32 v74, v74, v251
    v_mul_f32 v75, v75, v251
    v_mul_f32 v80, v80, v251
    v_mul_f32 v81, v81, v251
    v_mul_f32 v82, v82, v251
    v_mul_f32 v83, v83, v251
    v_mul_f32 v88, v88, v251
    v_mul_f32 v89, v89, v251
    v_mul_f32 v90, v90, v251
    v_mul_f32 v91, v91, v251
    v_mul_f32 v96, v96, v251
    v_mul_f32 v97, v97, v251
    v_mul_f32 v98, v98, v251
    v_mul_f32 v99, v99, v251
    v_mul_f32 v104, v104, v251
    v_mul_f32 v105, v105, v251
    v_mul_f32 v106, v106, v251
    v_mul_f32 v107, v107, v251
    v_mul_f32 v112, v112, v251
    v_mul_f32 v113, v113, v251
    v_mul_f32 v114, v114, v251
    v_mul_f32 v115, v115, v251
    v_mul_f32 v120, v120, v251
    v_mul_f32 v121, v121, v251
    v_mul_f32 v122, v122, v251
    v_mul_f32 v123, v123, v251
    v_lshlrev_b32 v4, 16, v0
    v_and_b32 v5, 0xffff0000, v0
    v_mul_f32 v4, v4, v251
    v_mul_f32 v5, v5, v251
    v_cvt_pk_bf16_f32 v0, v4, v5
    v_lshlrev_b32 v4, 16, v1
    v_and_b32 v5, 0xffff0000, v1
    v_mul_f32 v4, v4, v251
    v_mul_f32 v5, v5, v251
    v_cvt_pk_bf16_f32 v1, v4, v5
    v_lshlrev_b32 v4, 16, v2
    v_and_b32 v5, 0xffff0000, v2
    v_mul_f32 v4, v4, v251
    v_mul_f32 v5, v5, v251
    v_cvt_pk_bf16_f32 v2, v4, v5
    v_lshlrev_b32 v4, 16, v3
    v_and_b32 v5, 0xffff0000, v3
    v_mul_f32 v4, v4, v251
    v_mul_f32 v5, v5, v251
    v_cvt_pk_bf16_f32 v3, v4, v5
    v_lshlrev_b32 v20, 16, v16
    v_and_b32 v21, 0xffff0000, v16
    v_mul_f32 v20, v20, v251
    v_mul_f32 v21, v21, v251
    v_cvt_pk_bf16_f32 v16, v20, v21
    v_lshlrev_b32 v20, 16, v17
    v_and_b32 v21, 0xffff0000, v17
    v_mul_f32 v20, v20, v251
    v_mul_f32 v21, v21, v251
    v_cvt_pk_bf16_f32 v17, v20, v21
    v_lshlrev_b32 v20, 16, v18
    v_and_b32 v21, 0xffff0000, v18
    v_mul_f32 v20, v20, v251
    v_mul_f32 v21, v21, v251
    v_cvt_pk_bf16_f32 v18, v20, v21
    v_lshlrev_b32 v20, 16, v19
    v_and_b32 v21, 0xffff0000, v19
    v_mul_f32 v20, v20, v251
    v_mul_f32 v21, v21, v251
    v_cvt_pk_bf16_f32 v19, v20, v21
    v_mul_f32 v250, s31, v243
    v_min_f32 v250, v250, v245
    v_sub_f32 v251, v250, v245
    v_exp_f32 v251, v251
    v_mov_b32 v245, v250
    v_mul_f32 v247, v247, v251
    v_mul_f32 v68, v68, v251
    v_mul_f32 v69, v69, v251
    v_mul_f32 v70, v70, v251
    v_mul_f32 v71, v71, v251
    v_mul_f32 v76, v76, v251
    v_mul_f32 v77, v77, v251
    v_mul_f32 v78, v78, v251
    v_mul_f32 v79, v79, v251
    v_mul_f32 v84, v84, v251
    v_mul_f32 v85, v85, v251
    v_mul_f32 v86, v86, v251
    v_mul_f32 v87, v87, v251
    v_mul_f32 v92, v92, v251
    v_mul_f32 v93, v93, v251
    v_mul_f32 v94, v94, v251
    v_mul_f32 v95, v95, v251
    v_mul_f32 v100, v100, v251
    v_mul_f32 v101, v101, v251
    v_mul_f32 v102, v102, v251
    v_mul_f32 v103, v103, v251
    v_mul_f32 v108, v108, v251
    v_mul_f32 v109, v109, v251
    v_mul_f32 v110, v110, v251
    v_mul_f32 v111, v111, v251
    v_mul_f32 v116, v116, v251
    v_mul_f32 v117, v117, v251
    v_mul_f32 v118, v118, v251
    v_mul_f32 v119, v119, v251
    v_mul_f32 v124, v124, v251
    v_mul_f32 v125, v125, v251
    v_mul_f32 v126, v126, v251
    v_mul_f32 v127, v127, v251
    v_lshlrev_b32 v12, 16, v8
    v_and_b32 v13, 0xffff0000, v8
    v_mul_f32 v12, v12, v251
    v_mul_f32 v13, v13, v251
    v_cvt_pk_bf16_f32 v8, v12, v13
    v_lshlrev_b32 v12, 16, v9
    v_and_b32 v13, 0xffff0000, v9
    v_mul_f32 v12, v12, v251
    v_mul_f32 v13, v13, v251
    v_cvt_pk_bf16_f32 v9, v12, v13
    v_lshlrev_b32 v12, 16, v10
    v_and_b32 v13, 0xffff0000, v10
    v_mul_f32 v12, v12, v251
    v_mul_f32 v13, v13, v251
    v_cvt_pk_bf16_f32 v10, v12, v13
    v_lshlrev_b32 v12, 16, v11
    v_and_b32 v13, 0xffff0000, v11
    v_mul_f32 v12, v12, v251
    v_mul_f32 v13, v13, v251
    v_cvt_pk_bf16_f32 v11, v12, v13
    v_lshlrev_b32 v28, 16, v24
    v_and_b32 v29, 0xffff0000, v24
    v_mul_f32 v28, v28, v251
    v_mul_f32 v29, v29, v251
    v_cvt_pk_bf16_f32 v24, v28, v29
    v_lshlrev_b32 v28, 16, v25
    v_and_b32 v29, 0xffff0000, v25
    v_mul_f32 v28, v28, v251
    v_mul_f32 v29, v29, v251
    v_cvt_pk_bf16_f32 v25, v28, v29
    v_lshlrev_b32 v28, 16, v26
    v_and_b32 v29, 0xffff0000, v26
    v_mul_f32 v28, v28, v251
    v_mul_f32 v29, v29, v251
    v_cvt_pk_bf16_f32 v26, v28, v29
    v_lshlrev_b32 v28, 16, v27
    v_and_b32 v29, 0xffff0000, v27
    v_mul_f32 v28, v28, v251
    v_mul_f32 v29, v29, v251
    v_cvt_pk_bf16_f32 v27, v28, v29
    s_nop 3
    s_branch L_backL1
L_rareL2:
    s_nop 15
    v_mov_b32 v250, v242
    v_mov_b32 v251, v243
    s_nop 1
    v_permlane16_swap_b32 v250, v242
    s_nop 0
    v_permlane16_swap_b32 v251, v243
    s_nop 0
    v_max_f32 v242, v242, v250
    v_max_f32 v243, v243, v251
    v_mov_b32 v250, v242
    v_mov_b32 v251, v243
    s_nop 1
    v_permlane32_swap_b32 v250, v242
    s_nop 0
    v_permlane32_swap_b32 v251, v243
    s_nop 0
    v_max_f32 v242, v242, v250
    v_max_f32 v243, v243, v251
    v_mul_f32 v250, s31, v242
    v_min_f32 v250, v250, v244
    v_sub_f32 v251, v250, v244
    v_exp_f32 v251, v251
    v_mov_b32 v244, v250
    v_mul_f32 v246, v246, v251
    v_mul_f32 v64, v64, v251
    v_mul_f32 v65, v65, v251
    v_mul_f32 v66, v66, v251
    v_mul_f32 v67, v67, v251
    v_mul_f32 v72, v72, v251
    v_mul_f32 v73, v73, v251
    v_mul_f32 v74, v74, v251
    v_mul_f32 v75, v75, v251
    v_mul_f32 v80, v80, v251
    v_mul_f32 v81, v81, v251
    v_mul_f32 v82, v82, v251
    v_mul_f32 v83, v83, v251
    v_mul_f32 v88, v88, v251
    v_mul_f32 v89, v89, v251
    v_mul_f32 v90, v90, v251
    v_mul_f32 v91, v91, v251
    v_mul_f32 v96, v96, v251
    v_mul_f32 v97, v97, v251
    v_mul_f32 v98, v98, v251
    v_mul_f32 v99, v99, v251
    v_mul_f32 v104, v104, v251
    v_mul_f32 v105, v105, v251
    v_mul_f32 v106, v106, v251
    v_mul_f32 v107, v107, v251
    v_mul_f32 v112, v112, v251
    v_mul_f32 v113, v113, v251
    v_mul_f32 v114, v114, v251
    v_mul_f32 v115, v115, v251
    v_mul_f32 v120, v120, v251
    v_mul_f32 v121, v121, v251
    v_mul_f32 v122, v122, v251
    v_mul_f32 v123, v123, v251
    v_lshlrev_b32 v36, 16, v32
    v_and_b32 v37, 0xffff0000, v32
    v_mul_f32 v36, v36, v251
    v_mul_f32 v37, v37, v251
    v_cvt_pk_bf16_f32 v32, v36, v37
    v_lshlrev_b32 v36, 16, v33
    v_and_b32 v37, 0xffff0000, v33
    v_mul_f32 v36, v36, v251
    v_mul_f32 v37, v37, v251
    v_cvt_pk_bf16_f32 v33, v36, v37
    v_lshlrev_b32 v36, 16, v34
    v_and_b32 v37, 0xffff0000, v34
    v_mul_f32 v36, v36, v251
    v_mul_f32 v37, v37, v251
    v_cvt_pk_bf16_f32 v34, v36, v37
    v_lshlrev_b32 v36, 16, v35
    v_and_b32 v37, 0xffff0000, v35
    v_mul_f32 v36, v36, v251
    v_mul_f32 v37, v37, v251
    v_cvt_pk_bf16_f32 v35, v36, v37
    v_lshlrev_b32 v52, 16, v48
    v_and_b32 v53, 0xffff0000, v48
    v_mul_f32 v52, v52, v251
    v_mul_f32 v53, v53, v251
    v_cvt_pk_bf16_f32 v48, v52, v53
    v_lshlrev_b32 v52, 16, v49
    v_and_b32 v53, 0xffff0000, v49
    v_mul_f32 v52, v52, v251
    v_mul_f32 v53, v53, v251
    v_cvt_pk_bf16_f32 v49, v52, v53
    v_lshlrev_b32 v52, 16, v50
    v_and_b32 v53, 0xffff0000, v50
    v_mul_f32 v52, v52, v251
    v_mul_f32 v53, v53, v251
    v_cvt_pk_bf16_f32 v50, v52, v53
    v_lshlrev_b32 v52, 16, v51
    v_and_b32 v53, 0xffff0000, v51
    v_mul_f32 v52, v52, v251
    v_mul_f32 v53, v53, v251
    v_cvt_pk_bf16_f32 v51, v52, v53
    v_mul_f32 v250, s31, v243
    v_min_f32 v250, v250, v245
    v_sub_f32 v251, v250, v245
    v_exp_f32 v251, v251
    v_mov_b32 v245, v250
    v_mul_f32 v247, v247, v251
    v_mul_f32 v68, v68, v251
    v_mul_f32 v69, v69, v251
    v_mul_f32 v70, v70, v251
    v_mul_f32 v71, v71, v251
    v_mul_f32 v76, v76, v251
    v_mul_f32 v77, v77, v251
    v_mul_f32 v78, v78, v251
    v_mul_f32 v79, v79, v251
    v_mul_f32 v84, v84, v251
    v_mul_f32 v85, v85, v251
    v_mul_f32 v86, v86, v251
    v_mul_f32 v87, v87, v251
    v_mul_f32 v92, v92, v251
    v_mul_f32 v93, v93, v251
    v_mul_f32 v94, v94, v251
    v_mul_f32 v95, v95, v251
    v_mul_f32 v100, v100, v251
    v_mul_f32 v101, v101, v251
    v_mul_f32 v102, v102, v251
    v_mul_f32 v103, v103, v251
    v_mul_f32 v108, v108, v251
    v_mul_f32 v109, v109, v251
    v_mul_f32 v110, v110, v251
    v_mul_f32 v111, v111, v251
    v_mul_f32 v116, v116, v251
    v_mul_f32 v117, v117, v251
    v_mul_f32 v118, v118, v251
    v_mul_f32 v119, v119, v251
    v_mul_f32 v124, v124, v251
    v_mul_f32 v125, v125, v251
    v_mul_f32 v126, v126, v251
    v_mul_f32 v127, v127, v251
    v_lshlrev_b32 v44, 16, v40
    v_and_b32 v45, 0xffff0000, v40
    v_mul_f32 v44, v44, v251
    v_mul_f32 v45, v45, v251
    v_cvt_pk_bf16_f32 v40, v44, v45
    v_lshlrev_b32 v44, 16, v41
    v_and_b32 v45, 0xffff0000, v41
    v_mul_f32 v44, v44, v251
    v_mul_f32 v45, v45, v251
    v_cvt_pk_bf16_f32 v41, v44, v45
    v_lshlrev_b32 v44, 16, v42
    v_and_b32 v45, 0xffff0000, v42
    v_mul_f32 v44, v44, v251
    v_mul_f32 v45, v45, v251
    v_cvt_pk_bf16_f32 v42, v44, v45
    v_lshlrev_b32 v44, 16, v43
    v_and_b32 v45, 0xffff0000, v43
    v_mul_f32 v44, v44, v251
    v_mul_f32 v45, v45, v251
    v_cvt_pk_bf16_f32 v43, v44, v45
    v_lshlrev_b32 v60, 16, v56
    v_and_b32 v61, 0xffff0000, v56
    v_mul_f32 v60, v60, v251
    v_mul_f32 v61, v61, v251
    v_cvt_pk_bf16_f32 v56, v60, v61
    v_lshlrev_b32 v60, 16, v57
    v_and_b32 v61, 0xffff0000, v57
    v_mul_f32 v60, v60, v251
    v_mul_f32 v61, v61, v251
    v_cvt_pk_bf16_f32 v57, v60, v61
    v_lshlrev_b32 v60, 16, v58
    v_and_b32 v61, 0xffff0000, v58
    v_mul_f32 v60, v60, v251
    v_mul_f32 v61, v61, v251
    v_cvt_pk_bf16_f32 v58, v60, v61
    v_lshlrev_b32 v60, 16, v59
    v_and_b32 v61, 0xffff0000, v59
    v_mul_f32 v60, v60, v251
    v_mul_f32 v61, v61, v251
    v_cvt_pk_bf16_f32 v59, v60, v61
    s_nop 3
    s_branch L_backL2
L_rareL3:
    s_nop 15
    v_mov_b32 v250, v242
    v_mov_b32 v251, v243
    s_nop 1
    v_permlane16_swap_b32 v250, v242
    s_nop 0
    v_permlane16_swap_b32 v251, v243
    s_nop 0
    v_max_f32 v242, v242, v250
    v_max_f32 v243, v243, v251
    v_mov_b32 v250, v242
    v_mov_b32 v251, v243
    s_nop 1
    v_permlane32_swap_b32 v250, v242
    s_nop 0
    v_permlane32_swap_b32 v251, v243
    s_nop 0
    v_max_f32 v242, v242, v250
    v_max_f32 v243, v243, v251
    v_mul_f32 v250, s31, v242
    v_min_f32 v250, v250, v244
    v_sub_f32 v251, v250, v244
    v_exp_f32 v251, v251
    v_mov_b32 v244, v250
    v_mul_f32 v246, v246, v251
    v_mul_f32 v64, v64, v251
    v_mul_f32 v65, v65, v251
    v_mul_f32 v66, v66, v251
    v_mul_f32 v67, v67, v251
    v_mul_f32 v72, v72, v251
    v_mul_f32 v73, v73, v251
    v_mul_f32 v74, v74, v251
    v_mul_f32 v75, v75, v251
    v_mul_f32 v80, v80, v251
    v_mul_f32 v81, v81, v251
    v_mul_f32 v82, v82, v251
    v_mul_f32 v83, v83, v251
    v_mul_f32 v88, v88, v251
    v_mul_f32 v89, v89, v251
    v_mul_f32 v90, v90, v251
    v_mul_f32 v91, v91, v251
    v_mul_f32 v96, v96, v251
    v_mul_f32 v97, v97, v251
    v_mul_f32 v98, v98, v251
    v_mul_f32 v99, v99, v251
    v_mul_f32 v104, v104, v251
    v_mul_f32 v105, v105, v251
    v_mul_f32 v106, v106, v251
    v_mul_f32 v107, v107, v251
    v_mul_f32 v112, v112, v251
    v_mul_f32 v113, v113, v251
    v_mul_f32 v114, v114, v251
    v_mul_f32 v115, v115, v251
    v_mul_f32 v120, v120, v251
    v_mul_f32 v121, v121, v251
    v_mul_f32 v122, v122, v251
    v_mul_f32 v123, v123, v251
    v_lshlrev_b32 v4, 16, v0
    v_and_b32 v5, 0xffff0000, v0
    v_mul_f32 v4, v4, v251
    v_mul_f32 v5, v5, v251
    v_cvt_pk_bf16_f32 v0, v4, v5
    v_lshlrev_b32 v4, 16, v1
    v_and_b32 v5, 0xffff0000, v1
    v_mul_f32 v4, v4, v251
    v_mul_f32 v5, v5, v251
    v_cvt_pk_bf16_f32 v1, v4, v5
    v_lshlrev_b32 v4, 16, v2
    v_and_b32 v5, 0xffff0000, v2
    v_mul_f32 v4, v4, v251
    v_mul_f32 v5, v5, v251
    v_cvt_pk_bf16_f32 v2, v4, v5
    v_lshlrev_b32 v4, 16, v3
    v_and_b32 v5, 0xffff0000, v3
    v_mul_f32 v4, v4, v251
    v_mul_f32 v5, v5, v251
    v_cvt_pk_bf16_f32 v3, v4, v5
    v_lshlrev_b32 v20, 16, v16
    v_and_b32 v21, 0xffff0000, v16
    v_mul_f32 v20, v20, v251
    v_mul_f32 v21, v21, v251
    v_cvt_pk_bf16_f32 v16, v20, v21
    v_lshlrev_b32 v20, 16, v17
    v_and_b32 v21, 0xffff0000, v17
    v_mul_f32 v20, v20, v251
    v_mul_f32 v21, v21, v251
    v_cvt_pk_bf16_f32 v17, v20, v21
    v_lshlrev_b32 v20, 16, v18
    v_and_b32 v21, 0xffff0000, v18
    v_mul_f32 v20, v20, v251
    v_mul_f32 v21, v21, v251
    v_cvt_pk_bf16_f32 v18, v20, v21
    v_lshlrev_b32 v20, 16, v19
    v_and_b32 v21, 0xffff0000, v19
    v_mul_f32 v20, v20, v251
    v_mul_f32 v21, v21, v251
    v_cvt_pk_bf16_f32 v19, v20, v21
    v_mul_f32 v250, s31, v243
    v_min_f32 v250, v250, v245
    v_sub_f32 v251, v250, v245
    v_exp_f32 v251, v251
    v_mov_b32 v245, v250
    v_mul_f32 v247, v247, v251
    v_mul_f32 v68, v68, v251
    v_mul_f32 v69, v69, v251
    v_mul_f32 v70, v70, v251
    v_mul_f32 v71, v71, v251
    v_mul_f32 v76, v76, v251
    v_mul_f32 v77, v77, v251
    v_mul_f32 v78, v78, v251
    v_mul_f32 v79, v79, v251
    v_mul_f32 v84, v84, v251
    v_mul_f32 v85, v85, v251
    v_mul_f32 v86, v86, v251
    v_mul_f32 v87, v87, v251
    v_mul_f32 v92, v92, v251
    v_mul_f32 v93, v93, v251
    v_mul_f32 v94, v94, v251
    v_mul_f32 v95, v95, v251
    v_mul_f32 v100, v100, v251
    v_mul_f32 v101, v101, v251
    v_mul_f32 v102, v102, v251
    v_mul_f32 v103, v103, v251
    v_mul_f32 v108, v108, v251
    v_mul_f32 v109, v109, v251
    v_mul_f32 v110, v110, v251
    v_mul_f32 v111, v111, v251
    v_mul_f32 v116, v116, v251
    v_mul_f32 v117, v117, v251
    v_mul_f32 v118, v118, v251
    v_mul_f32 v119, v119, v251
    v_mul_f32 v124, v124, v251
    v_mul_f32 v125, v125, v251
    v_mul_f32 v126, v126, v251
    v_mul_f32 v127, v127, v251
    v_lshlrev_b32 v12, 16, v8
    v_and_b32 v13, 0xffff0000, v8
    v_mul_f32 v12, v12, v251
    v_mul_f32 v13, v13, v251
    v_cvt_pk_bf16_f32 v8, v12, v13
    v_lshlrev_b32 v12, 16, v9
    v_and_b32 v13, 0xffff0000, v9
    v_mul_f32 v12, v12, v251
    v_mul_f32 v13, v13, v251
    v_cvt_pk_bf16_f32 v9, v12, v13
    v_lshlrev_b32 v12, 16, v10
    v_and_b32 v13, 0xffff0000, v10
    v_mul_f32 v12, v12, v251
    v_mul_f32 v13, v13, v251
    v_cvt_pk_bf16_f32 v10, v12, v13
    v_lshlrev_b32 v12, 16, v11
    v_and_b32 v13, 0xffff0000, v11
    v_mul_f32 v12, v12, v251
    v_mul_f32 v13, v13, v251
    v_cvt_pk_bf16_f32 v11, v12, v13
    v_lshlrev_b32 v28, 16, v24
    v_and_b32 v29, 0xffff0000, v24
    v_mul_f32 v28, v28, v251
    v_mul_f32 v29, v29, v251
    v_cvt_pk_bf16_f32 v24, v28, v29
    v_lshlrev_b32 v28, 16, v25
    v_and_b32 v29, 0xffff0000, v25
    v_mul_f32 v28, v28, v251
    v_mul_f32 v29, v29, v251
    v_cvt_pk_bf16_f32 v25, v28, v29
    v_lshlrev_b32 v28, 16, v26
    v_and_b32 v29, 0xffff0000, v26
    v_mul_f32 v28, v28, v251
    v_mul_f32 v29, v29, v251
    v_cvt_pk_bf16_f32 v26, v28, v29
    v_lshlrev_b32 v28, 16, v27
    v_and_b32 v29, 0xffff0000, v27
    v_mul_f32 v28, v28, v251
    v_mul_f32 v29, v29, v251
    v_cvt_pk_bf16_f32 v27, v28, v29
    s_nop 3
    s_branch L_backL3
L_rareF1:
    s_nop 15
    v_mov_b32 v250, v242
    v_mov_b32 v251, v243
    s_nop 1
    v_permlane16_swap_b32 v250, v242
    s_nop 0
    v_permlane16_swap_b32 v251, v243
    s_nop 0
    v_max_f32 v242, v242, v250
    v_max_f32 v243, v243, v251
    v_mov_b32 v250, v242
    v_mov_b32 v251, v243
    s_nop 1
    v_permlane32_swap_b32 v250, v242
    s_nop 0
    v_permlane32_swap_b32 v251, v243
    s_nop 0
    v_max_f32 v242, v242, v250
    v_max_f32 v243, v243, v251
    v_mul_f32 v250, s31, v242
    v_min_f32 v250, v250, v244
    v_sub_f32 v251, v250, v244
    v_exp_f32 v251, v251
    v_mov_b32 v244, v250
    v_mul_f32 v246, v246, v251
    v_mul_f32 v64, v64, v251
    v_mul_f32 v65, v65, v251
    v_mul_f32 v66, v66, v251
    v_mul_f32 v67, v67, v251
    v_mul_f32 v72, v72, v251
    v_mul_f32 v73, v73, v251
    v_mul_f32 v74, v74, v251
    v_mul_f32 v75, v75, v251
    v_mul_f32 v80, v80, v251
    v_mul_f32 v81, v81, v251
    v_mul_f32 v82, v82, v251
    v_mul_f32 v83, v83, v251
    v_mul_f32 v88, v88, v251
    v_mul_f32 v89, v89, v251
    v_mul_f32 v90, v90, v251
    v_mul_f32 v91, v91, v251
    v_mul_f32 v96, v96, v251
    v_mul_f32 v97, v97, v251
    v_mul_f32 v98, v98, v251
    v_mul_f32 v99, v99, v251
    v_mul_f32 v104, v104, v251
    v_mul_f32 v105, v105, v251
    v_mul_f32 v106, v106, v251
    v_mul_f32 v107, v107, v251
    v_mul_f32 v112, v112, v251
    v_mul_f32 v113, v113, v251
    v_mul_f32 v114, v114, v251
    v_mul_f32 v115, v115, v251
    v_mul_f32 v120, v120, v251
    v_mul_f32 v121, v121, v251
    v_mul_f32 v122, v122, v251
    v_mul_f32 v123, v123, v251
    v_lshlrev_b32 v4, 16, v0
    v_and_b32 v5, 0xffff0000, v0
    v_mul_f32 v4, v4, v251
    v_mul_f32 v5, v5, v251
    v_cvt_pk_bf16_f32 v0, v4, v5
    v_lshlrev_b32 v4, 16, v1
    v_and_b32 v5, 0xffff0000, v1
    v_mul_f32 v4, v4, v251
    v_mul_f32 v5, v5, v251
    v_cvt_pk_bf16_f32 v1, v4, v5
    v_lshlrev_b32 v4, 16, v2
    v_and_b32 v5, 0xffff0000, v2
    v_mul_f32 v4, v4, v251
    v_mul_f32 v5, v5, v251
    v_cvt_pk_bf16_f32 v2, v4, v5
    v_lshlrev_b32 v4, 16, v3
    v_and_b32 v5, 0xffff0000, v3
    v_mul_f32 v4, v4, v251
    v_mul_f32 v5, v5, v251
    v_cvt_pk_bf16_f32 v3, v4, v5
    v_lshlrev_b32 v20, 16, v16
    v_and_b32 v21, 0xffff0000, v16
    v_mul_f32 v20, v20, v251
    v_mul_f32 v21, v21, v251
    v_cvt_pk_bf16_f32 v16, v20, v21
    v_lshlrev_b32 v20, 16, v17
    v_and_b32 v21, 0xffff0000, v17
    v_mul_f32 v20, v20, v251
    v_mul_f32 v21, v21, v251
    v_cvt_pk_bf16_f32 v17, v20, v21
    v_lshlrev_b32 v20, 16, v18
    v_and_b32 v21, 0xffff0000, v18
    v_mul_f32 v20, v20, v251
    v_mul_f32 v21, v21, v251
    v_cvt_pk_bf16_f32 v18, v20, v21
    v_lshlrev_b32 v20, 16, v19
    v_and_b32 v21, 0xffff0000, v19
    v_mul_f32 v20, v20, v251
    v_mul_f32 v21, v21, v251
    v_cvt_pk_bf16_f32 v19, v20, v21
    v_mul_f32 v250, s31, v243
    v_min_f32 v250, v250, v245
    v_sub_f32 v251, v250, v245
    v_exp_f32 v251, v251
    v_mov_b32 v245, v250
    v_mul_f32 v247, v247, v251
    v_mul_f32 v68, v68, v251
    v_mul_f32 v69, v69, v251
    v_mul_f32 v70, v70, v251
    v_mul_f32 v71, v71, v251
    v_mul_f32 v76, v76, v251
    v_mul_f32 v77, v77, v251
    v_mul_f32 v78, v78, v251
    v_mul_f32 v79, v79, v251
    v_mul_f32 v84, v84, v251
    v_mul_f32 v85, v85, v251
    v_mul_f32 v86, v86, v251
    v_mul_f32 v87, v87, v251
    v_mul_f32 v92, v92, v251
    v_mul_f32 v93, v93, v251
    v_mul_f32 v94, v94, v251
    v_mul_f32 v95, v95, v251
    v_mul_f32 v100, v100, v251
    v_mul_f32 v101, v101, v251
    v_mul_f32 v102, v102, v251
    v_mul_f32 v103, v103, v251
    v_mul_f32 v108, v108, v251
    v_mul_f32 v109, v109, v251
    v_mul_f32 v110, v110, v251
    v_mul_f32 v111, v111, v251
    v_mul_f32 v116, v116, v251
    v_mul_f32 v117, v117, v251
    v_mul_f32 v118, v118, v251
    v_mul_f32 v119, v119, v251
    v_mul_f32 v124, v124, v251
    v_mul_f32 v125, v125, v251
    v_mul_f32 v126, v126, v251
    v_mul_f32 v127, v127, v251
    v_lshlrev_b32 v12, 16, v8
    v_and_b32 v13, 0xffff0000, v8
    v_mul_f32 v12, v12, v251
    v_mul_f32 v13, v13, v251
    v_cvt_pk_bf16_f32 v8, v12, v13
    v_lshlrev_b32 v12, 16, v9
    v_and_b32 v13, 0xffff0000, v9
    v_mul_f32 v12, v12, v251
    v_mul_f32 v13, v13, v251
    v_cvt_pk_bf16_f32 v9, v12, v13
    v_lshlrev_b32 v12, 16, v10
    v_and_b32 v13, 0xffff0000, v10
    v_mul_f32 v12, v12, v251
    v_mul_f32 v13, v13, v251
    v_cvt_pk_bf16_f32 v10, v12, v13
    v_lshlrev_b32 v12, 16, v11
    v_and_b32 v13, 0xffff0000, v11
    v_mul_f32 v12, v12, v251
    v_mul_f32 v13, v13, v251
    v_cvt_pk_bf16_f32 v11, v12, v13
    v_lshlrev_b32 v28, 16, v24
    v_and_b32 v29, 0xffff0000, v24
    v_mul_f32 v28, v28, v251
    v_mul_f32 v29, v29, v251
    v_cvt_pk_bf16_f32 v24, v28, v29
    v_lshlrev_b32 v28, 16, v25
    v_and_b32 v29, 0xffff0000, v25
    v_mul_f32 v28, v28, v251
    v_mul_f32 v29, v29, v251
    v_cvt_pk_bf16_f32 v25, v28, v29
    v_lshlrev_b32 v28, 16, v26
    v_and_b32 v29, 0xffff0000, v26
    v_mul_f32 v28, v28, v251
    v_mul_f32 v29, v29, v251
    v_cvt_pk_bf16_f32 v26, v28, v29
    v_lshlrev_b32 v28, 16, v27
    v_and_b32 v29, 0xffff0000, v27
    v_mul_f32 v28, v28, v251
    v_mul_f32 v29, v29, v251
    v_cvt_pk_bf16_f32 v27, v28, v29
    s_nop 3
    s_branch L_backF1
L_rareF2:
    s_nop 15
    v_mov_b32 v250, v242
    v_mov_b32 v251, v243
    s_nop 1
    v_permlane16_swap_b32 v250, v242
    s_nop 0
    v_permlane16_swap_b32 v251, v243
    s_nop 0
    v_max_f32 v242, v242, v250
    v_max_f32 v243, v243, v251
    v_mov_b32 v250, v242
    v_mov_b32 v251, v243
    s_nop 1
    v_permlane32_swap_b32 v250, v242
    s_nop 0
    v_permlane32_swap_b32 v251, v243
    s_nop 0
    v_max_f32 v242, v242, v250
    v_max_f32 v243, v243, v251
    v_mul_f32 v250, s31, v242
    v_min_f32 v250, v250, v244
    v_sub_f32 v251, v250, v244
    v_exp_f32 v251, v251
    v_mov_b32 v244, v250
    v_mul_f32 v246, v246, v251
    v_mul_f32 v64, v64, v251
    v_mul_f32 v65, v65, v251
    v_mul_f32 v66, v66, v251
    v_mul_f32 v67, v67, v251
    v_mul_f32 v72, v72, v251
    v_mul_f32 v73, v73, v251
    v_mul_f32 v74, v74, v251
    v_mul_f32 v75, v75, v251
    v_mul_f32 v80, v80, v251
    v_mul_f32 v81, v81, v251
    v_mul_f32 v82, v82, v251
    v_mul_f32 v83, v83, v251
    v_mul_f32 v88, v88, v251
    v_mul_f32 v89, v89, v251
    v_mul_f32 v90, v90, v251
    v_mul_f32 v91, v91, v251
    v_mul_f32 v96, v96, v251
    v_mul_f32 v97, v97, v251
    v_mul_f32 v98, v98, v251
    v_mul_f32 v99, v99, v251
    v_mul_f32 v104, v104, v251
    v_mul_f32 v105, v105, v251
    v_mul_f32 v106, v106, v251
    v_mul_f32 v107, v107, v251
    v_mul_f32 v112, v112, v251
    v_mul_f32 v113, v113, v251
    v_mul_f32 v114, v114, v251
    v_mul_f32 v115, v115, v251
    v_mul_f32 v120, v120, v251
    v_mul_f32 v121, v121, v251
    v_mul_f32 v122, v122, v251
    v_mul_f32 v123, v123, v251
    v_lshlrev_b32 v36, 16, v32
    v_and_b32 v37, 0xffff0000, v32
    v_mul_f32 v36, v36, v251
    v_mul_f32 v37, v37, v251
    v_cvt_pk_bf16_f32 v32, v36, v37
    v_lshlrev_b32 v36, 16, v33
    v_and_b32 v37, 0xffff0000, v33
    v_mul_f32 v36, v36, v251
    v_mul_f32 v37, v37, v251
    v_cvt_pk_bf16_f32 v33, v36, v37
    v_lshlrev_b32 v36, 16, v34
    v_and_b32 v37, 0xffff0000, v34
    v_mul_f32 v36, v36, v251
    v_mul_f32 v37, v37, v251
    v_cvt_pk_bf16_f32 v34, v36, v37
    v_lshlrev_b32 v36, 16, v35
    v_and_b32 v37, 0xffff0000, v35
    v_mul_f32 v36, v36, v251
    v_mul_f32 v37, v37, v251
    v_cvt_pk_bf16_f32 v35, v36, v37
    v_lshlrev_b32 v52, 16, v48
    v_and_b32 v53, 0xffff0000, v48
    v_mul_f32 v52, v52, v251
    v_mul_f32 v53, v53, v251
    v_cvt_pk_bf16_f32 v48, v52, v53
    v_lshlrev_b32 v52, 16, v49
    v_and_b32 v53, 0xffff0000, v49
    v_mul_f32 v52, v52, v251
    v_mul_f32 v53, v53, v251
    v_cvt_pk_bf16_f32 v49, v52, v53
    v_lshlrev_b32 v52, 16, v50
    v_and_b32 v53, 0xffff0000, v50
    v_mul_f32 v52, v52, v251
    v_mul_f32 v53, v53, v251
    v_cvt_pk_bf16_f32 v50, v52, v53
    v_lshlrev_b32 v52, 16, v51
    v_and_b32 v53, 0xffff0000, v51
    v_mul_f32 v52, v52, v251
    v_mul_f32 v53, v53, v251
    v_cvt_pk_bf16_f32 v51, v52, v53
    v_mul_f32 v250, s31, v243
    v_min_f32 v250, v250, v245
    v_sub_f32 v251, v250, v245
    v_exp_f32 v251, v251
    v_mov_b32 v245, v250
    v_mul_f32 v247, v247, v251
    v_mul_f32 v68, v68, v251
    v_mul_f32 v69, v69, v251
    v_mul_f32 v70, v70, v251
    v_mul_f32 v71, v71, v251
    v_mul_f32 v76, v76, v251
    v_mul_f32 v77, v77, v251
    v_mul_f32 v78, v78, v251
    v_mul_f32 v79, v79, v251
    v_mul_f32 v84, v84, v251
    v_mul_f32 v85, v85, v251
    v_mul_f32 v86, v86, v251
    v_mul_f32 v87, v87, v251
    v_mul_f32 v92, v92, v251
    v_mul_f32 v93, v93, v251
    v_mul_f32 v94, v94, v251
    v_mul_f32 v95, v95, v251
    v_mul_f32 v100, v100, v251
    v_mul_f32 v101, v101, v251
    v_mul_f32 v102, v102, v251
    v_mul_f32 v103, v103, v251
    v_mul_f32 v108, v108, v251
    v_mul_f32 v109, v109, v251
    v_mul_f32 v110, v110, v251
    v_mul_f32 v111, v111, v251
    v_mul_f32 v116, v116, v251
    v_mul_f32 v117, v117, v251
    v_mul_f32 v118, v118, v251
    v_mul_f32 v119, v119, v251
    v_mul_f32 v124, v124, v251
    v_mul_f32 v125, v125, v251
    v_mul_f32 v126, v126, v251
    v_mul_f32 v127, v127, v251
    v_lshlrev_b32 v44, 16, v40
    v_and_b32 v45, 0xffff0000, v40
    v_mul_f32 v44, v44, v251
    v_mul_f32 v45, v45, v251
    v_cvt_pk_bf16_f32 v40, v44, v45
    v_lshlrev_b32 v44, 16, v41
    v_and_b32 v45, 0xffff0000, v41
    v_mul_f32 v44, v44, v251
    v_mul_f32 v45, v45, v251
    v_cvt_pk_bf16_f32 v41, v44, v45
    v_lshlrev_b32 v44, 16, v42
    v_and_b32 v45, 0xffff0000, v42
    v_mul_f32 v44, v44, v251
    v_mul_f32 v45, v45, v251
    v_cvt_pk_bf16_f32 v42, v44, v45
    v_lshlrev_b32 v44, 16, v43
    v_and_b32 v45, 0xffff0000, v43
    v_mul_f32 v44, v44, v251
    v_mul_f32 v45, v45, v251
    v_cvt_pk_bf16_f32 v43, v44, v45
    v_lshlrev_b32 v60, 16, v56
    v_and_b32 v61, 0xffff0000, v56
    v_mul_f32 v60, v60, v251
    v_mul_f32 v61, v61, v251
    v_cvt_pk_bf16_f32 v56, v60, v61
    v_lshlrev_b32 v60, 16, v57
    v_and_b32 v61, 0xffff0000, v57
    v_mul_f32 v60, v60, v251
    v_mul_f32 v61, v61, v251
    v_cvt_pk_bf16_f32 v57, v60, v61
    v_lshlrev_b32 v60, 16, v58
    v_and_b32 v61, 0xffff0000, v58
    v_mul_f32 v60, v60, v251
    v_mul_f32 v61, v61, v251
    v_cvt_pk_bf16_f32 v58, v60, v61
    v_lshlrev_b32 v60, 16, v59
    v_and_b32 v61, 0xffff0000, v59
    v_mul_f32 v60, v60, v251
    v_mul_f32 v61, v61, v251
    v_cvt_pk_bf16_f32 v59, v60, v61
    s_nop 3
    s_branch L_backF2
L_rareF3:
    s_nop 15
    v_mov_b32 v250, v242
    v_mov_b32 v251, v243
    s_nop 1
    v_permlane16_swap_b32 v250, v242
    s_nop 0
    v_permlane16_swap_b32 v251, v243
    s_nop 0
    v_max_f32 v242, v242, v250
    v_max_f32 v243, v243, v251
    v_mov_b32 v250, v242
    v_mov_b32 v251, v243
    s_nop 1
    v_permlane32_swap_b32 v250, v242
    s_nop 0
    v_permlane32_swap_b32 v251, v243
    s_nop 0
    v_max_f32 v242, v242, v250
    v_max_f32 v243, v243, v251
    v_mul_f32 v250, s31, v242
    v_min_f32 v250, v250, v244
    v_sub_f32 v251, v250, v244
    v_exp_f32 v251, v251
    v_mov_b32 v244, v250
    v_mul_f32 v246, v246, v251
    v_mul_f32 v64, v64, v251
    v_mul_f32 v65, v65, v251
    v_mul_f32 v66, v66, v251
    v_mul_f32 v67, v67, v251
    v_mul_f32 v72, v72, v251
    v_mul_f32 v73, v73, v251
    v_mul_f32 v74, v74, v251
    v_mul_f32 v75, v75, v251
    v_mul_f32 v80, v80, v251
    v_mul_f32 v81, v81, v251
    v_mul_f32 v82, v82, v251
    v_mul_f32 v83, v83, v251
    v_mul_f32 v88, v88, v251
    v_mul_f32 v89, v89, v251
    v_mul_f32 v90, v90, v251
    v_mul_f32 v91, v91, v251
    v_mul_f32 v96, v96, v251
    v_mul_f32 v97, v97, v251
    v_mul_f32 v98, v98, v251
    v_mul_f32 v99, v99, v251
    v_mul_f32 v104, v104, v251
    v_mul_f32 v105, v105, v251
    v_mul_f32 v106, v106, v251
    v_mul_f32 v107, v107, v251
    v_mul_f32 v112, v112, v251
    v_mul_f32 v113, v113, v251
    v_mul_f32 v114, v114, v251
    v_mul_f32 v115, v115, v251
    v_mul_f32 v120, v120, v251
    v_mul_f32 v121, v121, v251
    v_mul_f32 v122, v122, v251
    v_mul_f32 v123, v123, v251
    v_lshlrev_b32 v4, 16, v0
    v_and_b32 v5, 0xffff0000, v0
    v_mul_f32 v4, v4, v251
    v_mul_f32 v5, v5, v251
    v_cvt_pk_bf16_f32 v0, v4, v5
    v_lshlrev_b32 v4, 16, v1
    v_and_b32 v5, 0xffff0000, v1
    v_mul_f32 v4, v4, v251
    v_mul_f32 v5, v5, v251
    v_cvt_pk_bf16_f32 v1, v4, v5
    v_lshlrev_b32 v4, 16, v2
    v_and_b32 v5, 0xffff0000, v2
    v_mul_f32 v4, v4, v251
    v_mul_f32 v5, v5, v251
    v_cvt_pk_bf16_f32 v2, v4, v5
    v_lshlrev_b32 v4, 16, v3
    v_and_b32 v5, 0xffff0000, v3
    v_mul_f32 v4, v4, v251
    v_mul_f32 v5, v5, v251
    v_cvt_pk_bf16_f32 v3, v4, v5
    v_lshlrev_b32 v20, 16, v16
    v_and_b32 v21, 0xffff0000, v16
    v_mul_f32 v20, v20, v251
    v_mul_f32 v21, v21, v251
    v_cvt_pk_bf16_f32 v16, v20, v21
    v_lshlrev_b32 v20, 16, v17
    v_and_b32 v21, 0xffff0000, v17
    v_mul_f32 v20, v20, v251
    v_mul_f32 v21, v21, v251
    v_cvt_pk_bf16_f32 v17, v20, v21
    v_lshlrev_b32 v20, 16, v18
    v_and_b32 v21, 0xffff0000, v18
    v_mul_f32 v20, v20, v251
    v_mul_f32 v21, v21, v251
    v_cvt_pk_bf16_f32 v18, v20, v21
    v_lshlrev_b32 v20, 16, v19
    v_and_b32 v21, 0xffff0000, v19
    v_mul_f32 v20, v20, v251
    v_mul_f32 v21, v21, v251
    v_cvt_pk_bf16_f32 v19, v20, v21
    v_mul_f32 v250, s31, v243
    v_min_f32 v250, v250, v245
    v_sub_f32 v251, v250, v245
    v_exp_f32 v251, v251
    v_mov_b32 v245, v250
    v_mul_f32 v247, v247, v251
    v_mul_f32 v68, v68, v251
    v_mul_f32 v69, v69, v251
    v_mul_f32 v70, v70, v251
    v_mul_f32 v71, v71, v251
    v_mul_f32 v76, v76, v251
    v_mul_f32 v77, v77, v251
    v_mul_f32 v78, v78, v251
    v_mul_f32 v79, v79, v251
    v_mul_f32 v84, v84, v251
    v_mul_f32 v85, v85, v251
    v_mul_f32 v86, v86, v251
    v_mul_f32 v87, v87, v251
    v_mul_f32 v92, v92, v251
    v_mul_f32 v93, v93, v251
    v_mul_f32 v94, v94, v251
    v_mul_f32 v95, v95, v251
    v_mul_f32 v100, v100, v251
    v_mul_f32 v101, v101, v251
    v_mul_f32 v102, v102, v251
    v_mul_f32 v103, v103, v251
    v_mul_f32 v108, v108, v251
    v_mul_f32 v109, v109, v251
    v_mul_f32 v110, v110, v251
    v_mul_f32 v111, v111, v251
    v_mul_f32 v116, v116, v251
    v_mul_f32 v117, v117, v251
    v_mul_f32 v118, v118, v251
    v_mul_f32 v119, v119, v251
    v_mul_f32 v124, v124, v251
    v_mul_f32 v125, v125, v251
    v_mul_f32 v126, v126, v251
    v_mul_f32 v127, v127, v251
    v_lshlrev_b32 v12, 16, v8
    v_and_b32 v13, 0xffff0000, v8
    v_mul_f32 v12, v12, v251
    v_mul_f32 v13, v13, v251
    v_cvt_pk_bf16_f32 v8, v12, v13
    v_lshlrev_b32 v12, 16, v9
    v_and_b32 v13, 0xffff0000, v9
    v_mul_f32 v12, v12, v251
    v_mul_f32 v13, v13, v251
    v_cvt_pk_bf16_f32 v9, v12, v13
    v_lshlrev_b32 v12, 16, v10
    v_and_b32 v13, 0xffff0000, v10
    v_mul_f32 v12, v12, v251
    v_mul_f32 v13, v13, v251
    v_cvt_pk_bf16_f32 v10, v12, v13
    v_lshlrev_b32 v12, 16, v11
    v_and_b32 v13, 0xffff0000, v11
    v_mul_f32 v12, v12, v251
    v_mul_f32 v13, v13, v251
    v_cvt_pk_bf16_f32 v11, v12, v13
    v_lshlrev_b32 v28, 16, v24
    v_and_b32 v29, 0xffff0000, v24
    v_mul_f32 v28, v28, v251
    v_mul_f32 v29, v29, v251
    v_cvt_pk_bf16_f32 v24, v28, v29
    v_lshlrev_b32 v28, 16, v25
    v_and_b32 v29, 0xffff0000, v25
    v_mul_f32 v28, v28, v251
    v_mul_f32 v29, v29, v251
    v_cvt_pk_bf16_f32 v25, v28, v29
    v_lshlrev_b32 v28, 16, v26
    v_and_b32 v29, 0xffff0000, v26
    v_mul_f32 v28, v28, v251
    v_mul_f32 v29, v29, v251
    v_cvt_pk_bf16_f32 v26, v28, v29
    v_lshlrev_b32 v28, 16, v27
    v_and_b32 v29, 0xffff0000, v27
    v_mul_f32 v28, v28, v251
    v_mul_f32 v29, v29, v251
    v_cvt_pk_bf16_f32 v27, v28, v29
    s_nop 3
    s_branch L_backF3
L_end:
    s_endpgm
.section .rodata,"a"
.p2align 6
.amdhsa_kernel standalone__gqa_softmax__near_ridge_kernel
  .amdhsa_next_free_vgpr 256
  .amdhsa_next_free_sgpr 64
  .amdhsa_accum_offset 256
  .amdhsa_group_segment_fixed_size 0
  .amdhsa_kernarg_size 48
  .amdhsa_user_sgpr_count 2
  .amdhsa_user_sgpr_kernarg_segment_ptr 1
  .amdhsa_system_sgpr_workgroup_id_x 1
.end_amdhsa_kernel
```
